```python
import torch

def _softmax(x, axis=-1):
    return torch.softmax(x, dim=axis)
def _gelu(x):
    return torch.nn.functional.gelu(x, approximate="tanh")
def _silu(x):
    return torch.nn.functional.silu(x)
def _sigmoid(x):
    return torch.sigmoid(x)
def _layernorm(x, axis=-1, eps=1e-5):
    m = x.mean(dim=axis, keepdim=True)
    v = x.var(dim=axis, keepdim=True, unbiased=False)
    return (x - m) / torch.sqrt(v + eps)
def _scatter_add(tgt, idx, src, axis=0):
    return tgt.clone().index_add_(axis, idx, src)
def _segment_sum(src, seg, n):
    out = torch.zeros((n,) + src.shape[1:], dtype=src.dtype)
    return out.index_add_(0, seg, src)
def _pad(x, pw):
    flat = tuple(v for pair in reversed(pw) for v in pair)
    return torch.nn.functional.pad(x, flat)

kernel_name = 'sequential_preLN__gqa_block_cached__geglu_ffn__decode'

def setup_inputs():

    _w = (lambda a: (lambda t: t.to(torch.bfloat16) if t.is_floating_point() else t)(torch.as_tensor(a)))
    def _A_setup():
        B, Sq, D = 1, 1, 1024
        Hq, Hkv, Sk, Dh = 32, 4, 65536, 128
        assert Hq % Hkv == 0, (Hq, Hkv)
        return {
            "x": _w((lambda *s: torch.randn(*s, dtype=torch.bfloat16) * 0.05)(B, Sq, D)),
            "k_cache": _w((lambda *s: torch.randn(*s, dtype=torch.bfloat16) * 3.2)(B, Hkv, Sk, Dh)),
            "v_cache": _w((lambda *s: torch.randn(*s, dtype=torch.bfloat16) * 0.4)(B, Hkv, Sk, Dh)),
            "wq": _w((lambda *s: torch.randn(*s, dtype=torch.bfloat16) * 3.2)(D, Hq * Dh) * (D ** -0.5)),
            "wo": _w((lambda *s: torch.randn(*s, dtype=torch.bfloat16) * 0.4)(Hq * Dh, D) * ((Hq * Dh) ** -0.5)),
        }
    _A_in = _A_setup()

    def _B_setup():
        B, S, D, F = 1, 1, 1024, 3584
        return {
            "x": _w((lambda *s: torch.randn(*s, dtype=torch.bfloat16) * 0.05)(B, S, D)),
            "w_gate": _w((lambda *s: torch.randn(*s, dtype=torch.bfloat16) * 0.05)(D, F)),
            "w_up": _w((lambda *s: torch.randn(*s, dtype=torch.bfloat16) * 0.05)(D, F)),
            "w_down": _w((lambda *s: torch.randn(*s, dtype=torch.bfloat16) * 0.05)(F, D)),
        }
    _B_in = _B_setup()

    return {
        "A_x": _A_in["x"],
        "A_k_cache": _A_in["k_cache"],
        "A_v_cache": _A_in["v_cache"],
        "A_wq": _A_in["wq"],
        "A_wo": _A_in["wo"],
        "B_x": _B_in["x"],
        "B_w_gate": _B_in["w_gate"],
        "B_w_up": _B_in["w_up"],
        "B_w_down": _B_in["w_down"],
    }

def reference(A_x, A_k_cache, A_v_cache, A_wq, A_wo, B_x, B_w_gate, B_w_up, B_w_down):
    def _A_ref(x, k_cache, v_cache, wq, wo):
        B, Sq, D = x.shape
        Hq, Dh = 32, 128
        Hkv = k_cache.shape[1]
        rep = Hq // Hkv
        q = (lambda x, *d: x.permute(*d))((x @ wq).reshape(B, Sq, Hq, Dh), 0, 2, 1, 3)
        k = (lambda x, n, axis: torch.repeat_interleave(x, n, dim=axis))(k_cache, rep, axis=1)
        v = (lambda x, n, axis: torch.repeat_interleave(x, n, dim=axis))(v_cache, rep, axis=1)
        scores = torch.einsum("bhqd,bhkd->bhqk", q, k) * (Dh ** -0.5)
        p = _softmax(scores, axis=-1)
        o = torch.einsum("bhqk,bhkd->bhqd", p, v)
        return (lambda x, *d: x.permute(*d))(o, 0, 2, 1, 3).reshape(B, Sq, Hq * Dh) @ wo

    def _B_ref(x, w_gate, w_up, w_down):
        return (_gelu(x @ w_gate) * (x @ w_up)) @ w_down

    x = A_x
    h = x + _A_ref(_layernorm(x, axis=-1), A_k_cache, A_v_cache, A_wq, A_wo)
    h2 = h + _B_ref(_layernorm(h, axis=-1), B_w_gate, B_w_up, B_w_down)
    return h2
```

```asm
; @launch grid=(256,1,1) block=(512,1,1) lds=64000
.amdgcn_target "amdgcn-amd-amdhsa--gfx950"
.text
.globl sequential_preLN__gqa_block_cached__geglu_ffn__decode_kernel
.p2align 8
.type sequential_preLN__gqa_block_cached__geglu_ffn__decode_kernel,@function
sequential_preLN__gqa_block_cached__geglu_ffn__decode_kernel:
    s_cmp_ge_u32 s2, 256
    s_cbranch_scc1 L_end
    s_load_dwordx2 s[8:9], s[0:1], 8
    s_mov_b32 s10, 67108864
    s_mov_b32 s11, 0x20000
    s_load_dwordx2 s[12:13], s[0:1], 16
    s_mov_b32 s14, 67108864
    s_mov_b32 s15, 0x20000
    s_load_dwordx2 s[16:17], s[0:1], 24
    s_mov_b32 s18, 8388608
    s_mov_b32 s19, 0x20000
    s_load_dwordx2 s[40:41], s[0:1], 0
    s_mov_b32 s42, 2048
    s_mov_b32 s43, 0x20000
    s_load_dwordx2 s[36:37], s[0:1], 88
    s_mov_b32 s38, 268435456
    s_mov_b32 s39, 0x20000
    v_lshrrev_b32 v1, 6, v0
    v_and_b32 v2, 63, v0
    v_readfirstlane_b32 s3, v1
    v_lshlrev_b32 v3, 2, v2
    v_mov_b32 v4, 0
    s_cmp_eq_u32 s3, 0
    s_cbranch_scc0 L_noinit
    ds_write_b32 v3, v4
L_noinit:
    s_mov_b32 s52, 0x05040100
    s_mov_b32 s53, 0x07060302
    s_mov_b32 s54, 1069066811
    s_cmp_ge_u32 s3, 4
    s_cbranch_scc1 L_helper
    s_lshr_b32 s57, s2, 6
    s_lshl_b32 s56, s57, 24
    s_and_b32 s57, s2, 63
    s_lshl_b32 s57, s57, 18
    s_add_u32 s56, s56, s57
    s_lshl_b32 s57, s3, 12
    s_add_u32 s56, s56, s57
    s_add_u32 s61, s56, 16384
    v_and_b32 v8, 15, v2
    v_lshrrev_b32 v11, 4, v2
    v_lshlrev_b32 v9, 8, v8
    v_lshlrev_b32 v12, 4, v11
    v_add_u32 v1, v9, v12
    v_lshlrev_b32 v11, 10, v11
    v_lshlrev_b32 v8, 4, v8
    v_add_u32 v3, v11, v8
    s_waitcnt lgkmcnt(0)
    s_waitcnt vmcnt(4)
    buffer_load_dwordx4 v[64:67], v1, s[8:11], s56 offen offset:0 nt
    buffer_load_dwordx4 v[68:71], v1, s[8:11], s56 offen offset:64 nt
    buffer_load_dwordx4 v[72:75], v1, s[8:11], s56 offen offset:128 nt
    buffer_load_dwordx4 v[76:79], v1, s[8:11], s56 offen offset:192 nt
    s_waitcnt vmcnt(4)
    buffer_load_dwordx4 v[96:99], v3, s[12:15], s56 offen offset:0 nt
    buffer_load_dwordx4 v[100:103], v3, s[12:15], s56 offen offset:256 nt
    buffer_load_dwordx4 v[104:107], v3, s[12:15], s56 offen offset:512 nt
    buffer_load_dwordx4 v[108:111], v3, s[12:15], s56 offen offset:768 nt
    s_barrier
    s_waitcnt vmcnt(4)
    buffer_load_dwordx4 v[80:83], v1, s[8:11], s61 offen offset:0 nt
    buffer_load_dwordx4 v[84:87], v1, s[8:11], s61 offen offset:64 nt
    buffer_load_dwordx4 v[88:91], v1, s[8:11], s61 offen offset:128 nt
    buffer_load_dwordx4 v[92:95], v1, s[8:11], s61 offen offset:192 nt
    s_waitcnt vmcnt(4)
    buffer_load_dwordx4 v[112:115], v3, s[12:15], s61 offen offset:0 nt
    buffer_load_dwordx4 v[116:119], v3, s[12:15], s61 offen offset:256 nt
    buffer_load_dwordx4 v[120:123], v3, s[12:15], s61 offen offset:512 nt
    buffer_load_dwordx4 v[124:127], v3, s[12:15], s61 offen offset:768 nt
    s_add_u32 s56, s56, 32768
    s_add_u32 s61, s61, 32768
    s_waitcnt vmcnt(4)
    buffer_load_dwordx4 v[128:131], v1, s[8:11], s56 offen offset:0 nt
    buffer_load_dwordx4 v[132:135], v1, s[8:11], s56 offen offset:64 nt
    buffer_load_dwordx4 v[136:139], v1, s[8:11], s56 offen offset:128 nt
    buffer_load_dwordx4 v[140:143], v1, s[8:11], s56 offen offset:192 nt
    s_waitcnt vmcnt(4)
    buffer_load_dwordx4 v[160:163], v3, s[12:15], s56 offen offset:0 nt
    buffer_load_dwordx4 v[164:167], v3, s[12:15], s56 offen offset:256 nt
    buffer_load_dwordx4 v[168:171], v3, s[12:15], s56 offen offset:512 nt
    buffer_load_dwordx4 v[172:175], v3, s[12:15], s56 offen offset:768 nt
    s_waitcnt vmcnt(4)
    buffer_load_dwordx4 v[144:147], v1, s[8:11], s61 offen offset:0 nt
    buffer_load_dwordx4 v[148:151], v1, s[8:11], s61 offen offset:64 nt
    buffer_load_dwordx4 v[152:155], v1, s[8:11], s61 offen offset:128 nt
    buffer_load_dwordx4 v[156:159], v1, s[8:11], s61 offen offset:192 nt
    s_waitcnt vmcnt(4)
    buffer_load_dwordx4 v[176:179], v3, s[12:15], s61 offen offset:0 nt
    buffer_load_dwordx4 v[180:183], v3, s[12:15], s61 offen offset:256 nt
    buffer_load_dwordx4 v[184:187], v3, s[12:15], s61 offen offset:512 nt
    buffer_load_dwordx4 v[188:191], v3, s[12:15], s61 offen offset:768 nt
    s_add_u32 s56, s56, 32768
    s_add_u32 s61, s61, 32768
    s_waitcnt vmcnt(4)
    buffer_load_dwordx4 v[192:195], v1, s[8:11], s56 offen offset:0 nt
    buffer_load_dwordx4 v[196:199], v1, s[8:11], s56 offen offset:64 nt
    buffer_load_dwordx4 v[200:203], v1, s[8:11], s56 offen offset:128 nt
    buffer_load_dwordx4 v[204:207], v1, s[8:11], s56 offen offset:192 nt
    s_waitcnt vmcnt(4)
    buffer_load_dwordx4 v[224:227], v3, s[12:15], s56 offen offset:0 nt
    buffer_load_dwordx4 v[228:231], v3, s[12:15], s56 offen offset:256 nt
    buffer_load_dwordx4 v[232:235], v3, s[12:15], s56 offen offset:512 nt
    buffer_load_dwordx4 v[236:239], v3, s[12:15], s56 offen offset:768 nt
    s_waitcnt vmcnt(4)
    buffer_load_dwordx4 v[208:211], v1, s[8:11], s61 offen offset:0 nt
    buffer_load_dwordx4 v[212:215], v1, s[8:11], s61 offen offset:64 nt
    buffer_load_dwordx4 v[216:219], v1, s[8:11], s61 offen offset:128 nt
    buffer_load_dwordx4 v[220:223], v1, s[8:11], s61 offen offset:192 nt
    s_waitcnt vmcnt(4)
    buffer_load_dwordx4 v[240:243], v3, s[12:15], s61 offen offset:0 nt
    buffer_load_dwordx4 v[244:247], v3, s[12:15], s61 offen offset:256 nt
    buffer_load_dwordx4 v[248:251], v3, s[12:15], s61 offen offset:512 nt
    buffer_load_dwordx4 v[252:255], v3, s[12:15], s61 offen offset:768 nt
    s_add_u32 s56, s56, 32768
    s_add_u32 s61, s61, 32768
    s_load_dwordx2 s[32:33], s[0:1], 64
    s_mov_b32 s34, 7340032
    s_mov_b32 s35, 0x20000
    s_load_dword s49, s[36:37], 0
    s_mov_b32 s50, 0xffffff00
    s_waitcnt lgkmcnt(0)
    s_add_u32 s49, s49, 1
    s_and_b32 s48, s49, 0xff
    v_mov_b32 v6, 0
    v_mov_b32 v7, 1
    v_mov_b32 v4, 0xff7fffff
    v_mov_b32 v5, 0
    v_mov_b32 v32, 0
    v_mov_b32 v33, 0
    v_mov_b32 v34, 0
    v_mov_b32 v35, 0
    v_mov_b32 v36, 0
    v_mov_b32 v37, 0
    v_mov_b32 v38, 0
    v_mov_b32 v39, 0
    v_mov_b32 v40, 0
    v_mov_b32 v41, 0
    v_mov_b32 v42, 0
    v_mov_b32 v43, 0
    v_mov_b32 v44, 0
    v_mov_b32 v45, 0
    v_mov_b32 v46, 0
    v_mov_b32 v47, 0
    v_mov_b32 v48, 0
    v_mov_b32 v49, 0
    v_mov_b32 v50, 0
    v_mov_b32 v51, 0
    v_mov_b32 v52, 0
    v_mov_b32 v53, 0
    v_mov_b32 v54, 0
    v_mov_b32 v55, 0
    v_mov_b32 v56, 0
    v_mov_b32 v57, 0
    v_mov_b32 v58, 0
    v_mov_b32 v59, 0
    v_mov_b32 v60, 0
    v_mov_b32 v61, 0
    v_mov_b32 v62, 0
    v_mov_b32 v63, 0
L_lw_1:
    ds_read_b32 v8, v6 offset:4
    s_waitcnt lgkmcnt(0)
    v_readfirstlane_b32 s79, v8
    s_nop 0
    s_cmp_ge_u32 s79, 4
    s_cbranch_scc1 L_lwd_2
    s_sleep 1
    s_branch L_lw_1
L_lwd_2:
    v_and_b32 v8, 7, v2
    v_mul_u32_u24 v8, 272, v8
    v_lshrrev_b32 v9, 4, v2
    v_lshlrev_b32 v9, 4, v9
    v_add_u32 v8, v8, v9
    ds_read_b128 v[16:19], v8 offset:256
    ds_read_b128 v[20:23], v8 offset:320
    ds_read_b128 v[24:27], v8 offset:384
    ds_read_b128 v[28:31], v8 offset:448
    s_waitcnt lgkmcnt(0)
    s_waitcnt vmcnt(36)
    v_mfma_f32_16x16x32_bf16 v[8:11], v[64:67], v[16:19], 0
    v_mfma_f32_16x16x32_bf16 v[12:15], v[80:83], v[16:19], 0
    v_mfma_f32_16x16x32_bf16 v[8:11], v[68:71], v[20:23], v[8:11]
    v_mfma_f32_16x16x32_bf16 v[12:15], v[84:87], v[20:23], v[12:15]
    v_mfma_f32_16x16x32_bf16 v[8:11], v[72:75], v[24:27], v[8:11]
    v_mfma_f32_16x16x32_bf16 v[12:15], v[88:91], v[24:27], v[12:15]
    v_mfma_f32_16x16x32_bf16 v[8:11], v[76:79], v[28:31], v[8:11]
    v_mfma_f32_16x16x32_bf16 v[12:15], v[92:95], v[28:31], v[12:15]
    s_nop 6
    v_cvt_pk_bf16_f32 v64, v8, v9
    v_cvt_pk_bf16_f32 v65, v10, v11
    v_cvt_pk_bf16_f32 v66, v12, v13
    v_cvt_pk_bf16_f32 v67, v14, v15
    v_lshlrev_b32 v8, 16, v64
    v_and_b32 v9, 0xffff0000, v64
    v_lshlrev_b32 v10, 16, v65
    v_and_b32 v11, 0xffff0000, v65
    v_lshlrev_b32 v12, 16, v66
    v_and_b32 v13, 0xffff0000, v66
    v_lshlrev_b32 v14, 16, v67
    v_and_b32 v15, 0xffff0000, v67
    v_mul_f32 v8, 1035273459, v8
    v_mul_f32 v9, 1035273459, v9
    v_mul_f32 v10, 1035273459, v10
    v_mul_f32 v11, 1035273459, v11
    v_mul_f32 v12, 1035273459, v12
    v_mul_f32 v13, 1035273459, v13
    v_mul_f32 v14, 1035273459, v14
    v_mul_f32 v15, 1035273459, v15
    v_cvt_pk_bf16_f32 v64, v8, v9
    v_cvt_pk_bf16_f32 v65, v10, v11
    v_cvt_pk_bf16_f32 v66, v12, v13
    v_cvt_pk_bf16_f32 v67, v14, v15
    v_lshlrev_b32 v8, 16, v64
    v_and_b32 v9, 0xffff0000, v64
    v_lshlrev_b32 v10, 16, v65
    v_and_b32 v11, 0xffff0000, v65
    v_lshlrev_b32 v12, 16, v66
    v_and_b32 v13, 0xffff0000, v66
    v_lshlrev_b32 v14, 16, v67
    v_and_b32 v15, 0xffff0000, v67
    v_max3_f32 v68, v8, v9, v10
    v_max3_f32 v69, v11, v12, v13
    v_max3_f32 v68, v68, v14, v15
    v_max3_f32 v68, v68, v69, v4
    v_mov_b32 v69, v68
    s_nop 1
    v_permlane16_swap_b32 v69, v68
    v_max_f32 v68, v68, v69
    v_mov_b32 v69, v68
    s_nop 1
    v_permlane32_swap_b32 v69, v68
    v_max_f32 v68, v68, v69
    v_sub_f32 v70, v4, v68
    v_mul_f32 v70, s54, v70
    v_exp_f32 v70, v70
    v_mov_b32 v4, v68
    v_mul_f32 v71, s54, v68
    v_fma_f32 v8, v8, s54, -v71
    v_fma_f32 v9, v9, s54, -v71
    v_fma_f32 v10, v10, s54, -v71
    v_fma_f32 v11, v11, s54, -v71
    v_fma_f32 v12, v12, s54, -v71
    v_fma_f32 v13, v13, s54, -v71
    v_fma_f32 v14, v14, s54, -v71
    v_fma_f32 v15, v15, s54, -v71
    v_exp_f32 v8, v8
    v_exp_f32 v9, v9
    v_exp_f32 v10, v10
    v_exp_f32 v11, v11
    v_exp_f32 v12, v12
    v_exp_f32 v13, v13
    v_exp_f32 v14, v14
    v_exp_f32 v15, v15
    v_pk_mul_f32 v[32:33], v[32:33], v[70:71] op_sel_hi:[1,0]
    v_pk_mul_f32 v[34:35], v[34:35], v[70:71] op_sel_hi:[1,0]
    v_pk_mul_f32 v[36:37], v[36:37], v[70:71] op_sel_hi:[1,0]
    v_pk_mul_f32 v[38:39], v[38:39], v[70:71] op_sel_hi:[1,0]
    v_pk_mul_f32 v[40:41], v[40:41], v[70:71] op_sel_hi:[1,0]
    v_pk_mul_f32 v[42:43], v[42:43], v[70:71] op_sel_hi:[1,0]
    v_pk_mul_f32 v[44:45], v[44:45], v[70:71] op_sel_hi:[1,0]
    v_pk_mul_f32 v[46:47], v[46:47], v[70:71] op_sel_hi:[1,0]
    v_pk_mul_f32 v[48:49], v[48:49], v[70:71] op_sel_hi:[1,0]
    v_pk_mul_f32 v[50:51], v[50:51], v[70:71] op_sel_hi:[1,0]
    v_pk_mul_f32 v[52:53], v[52:53], v[70:71] op_sel_hi:[1,0]
    v_pk_mul_f32 v[54:55], v[54:55], v[70:71] op_sel_hi:[1,0]
    v_pk_mul_f32 v[56:57], v[56:57], v[70:71] op_sel_hi:[1,0]
    v_pk_mul_f32 v[58:59], v[58:59], v[70:71] op_sel_hi:[1,0]
    v_pk_mul_f32 v[60:61], v[60:61], v[70:71] op_sel_hi:[1,0]
    v_pk_mul_f32 v[62:63], v[62:63], v[70:71] op_sel_hi:[1,0]
    v_cvt_pk_bf16_f32 v72, v8, v9
    v_cvt_pk_bf16_f32 v73, v10, v11
    v_cvt_pk_bf16_f32 v74, v12, v13
    v_cvt_pk_bf16_f32 v75, v14, v15
    v_add_f32 v8, v8, v9
    v_add_f32 v10, v10, v11
    v_add_f32 v12, v12, v13
    v_add_f32 v14, v14, v15
    v_add_f32 v8, v8, v10
    v_add_f32 v12, v12, v14
    v_add_f32 v8, v8, v12
    v_fma_f32 v5, v5, v70, v8
    s_waitcnt vmcnt(32)
    v_perm_b32 v80, v100, v96, s52
    v_perm_b32 v84, v100, v96, s53
    v_perm_b32 v81, v108, v104, s52
    v_perm_b32 v85, v108, v104, s53
    v_perm_b32 v82, v116, v112, s52
    v_perm_b32 v86, v116, v112, s53
    v_perm_b32 v83, v124, v120, s52
    v_perm_b32 v87, v124, v120, s53
    s_nop 0
    v_mfma_f32_16x16x32_bf16 v[32:35], v[80:83], v[72:75], v[32:35]
    v_mfma_f32_16x16x32_bf16 v[36:39], v[84:87], v[72:75], v[36:39]
    v_perm_b32 v88, v101, v97, s52
    v_perm_b32 v92, v101, v97, s53
    v_perm_b32 v89, v109, v105, s52
    v_perm_b32 v93, v109, v105, s53
    v_perm_b32 v90, v117, v113, s52
    v_perm_b32 v94, v117, v113, s53
    v_perm_b32 v91, v125, v121, s52
    v_perm_b32 v95, v125, v121, s53
    s_nop 0
    v_mfma_f32_16x16x32_bf16 v[40:43], v[88:91], v[72:75], v[40:43]
    v_mfma_f32_16x16x32_bf16 v[44:47], v[92:95], v[72:75], v[44:47]
    v_perm_b32 v80, v102, v98, s52
    v_perm_b32 v84, v102, v98, s53
    v_perm_b32 v81, v110, v106, s52
    v_perm_b32 v85, v110, v106, s53
    v_perm_b32 v82, v118, v114, s52
    v_perm_b32 v86, v118, v114, s53
    v_perm_b32 v83, v126, v122, s52
    v_perm_b32 v87, v126, v122, s53
    s_nop 0
    v_mfma_f32_16x16x32_bf16 v[48:51], v[80:83], v[72:75], v[48:51]
    v_mfma_f32_16x16x32_bf16 v[52:55], v[84:87], v[72:75], v[52:55]
    v_perm_b32 v88, v103, v99, s52
    v_perm_b32 v92, v103, v99, s53
    v_perm_b32 v89, v111, v107, s52
    v_perm_b32 v93, v111, v107, s53
    v_perm_b32 v90, v119, v115, s52
    v_perm_b32 v94, v119, v115, s53
    v_perm_b32 v91, v127, v123, s52
    v_perm_b32 v95, v127, v123, s53
    s_nop 0
    v_mfma_f32_16x16x32_bf16 v[56:59], v[88:91], v[72:75], v[56:59]
    v_mfma_f32_16x16x32_bf16 v[60:63], v[92:95], v[72:75], v[60:63]
    s_waitcnt vmcnt(4)
    buffer_load_dwordx4 v[64:67], v1, s[8:11], s56 offen offset:0 nt
    buffer_load_dwordx4 v[68:71], v1, s[8:11], s56 offen offset:64 nt
    buffer_load_dwordx4 v[72:75], v1, s[8:11], s56 offen offset:128 nt
    buffer_load_dwordx4 v[76:79], v1, s[8:11], s56 offen offset:192 nt
    s_waitcnt vmcnt(4)
    buffer_load_dwordx4 v[96:99], v3, s[12:15], s56 offen offset:0 nt
    buffer_load_dwordx4 v[100:103], v3, s[12:15], s56 offen offset:256 nt
    buffer_load_dwordx4 v[104:107], v3, s[12:15], s56 offen offset:512 nt
    buffer_load_dwordx4 v[108:111], v3, s[12:15], s56 offen offset:768 nt
    s_waitcnt vmcnt(4)
    buffer_load_dwordx4 v[80:83], v1, s[8:11], s61 offen offset:0 nt
    buffer_load_dwordx4 v[84:87], v1, s[8:11], s61 offen offset:64 nt
    buffer_load_dwordx4 v[88:91], v1, s[8:11], s61 offen offset:128 nt
    buffer_load_dwordx4 v[92:95], v1, s[8:11], s61 offen offset:192 nt
    s_waitcnt vmcnt(4)
    buffer_load_dwordx4 v[112:115], v3, s[12:15], s61 offen offset:0 nt
    buffer_load_dwordx4 v[116:119], v3, s[12:15], s61 offen offset:256 nt
    buffer_load_dwordx4 v[120:123], v3, s[12:15], s61 offen offset:512 nt
    buffer_load_dwordx4 v[124:127], v3, s[12:15], s61 offen offset:768 nt
    s_add_u32 s56, s56, 32768
    s_add_u32 s61, s61, 32768
    s_waitcnt vmcnt(36)
    v_mfma_f32_16x16x32_bf16 v[8:11], v[128:131], v[16:19], 0
    v_mfma_f32_16x16x32_bf16 v[12:15], v[144:147], v[16:19], 0
    v_mfma_f32_16x16x32_bf16 v[8:11], v[132:135], v[20:23], v[8:11]
    v_mfma_f32_16x16x32_bf16 v[12:15], v[148:151], v[20:23], v[12:15]
    v_mfma_f32_16x16x32_bf16 v[8:11], v[136:139], v[24:27], v[8:11]
    v_mfma_f32_16x16x32_bf16 v[12:15], v[152:155], v[24:27], v[12:15]
    v_mfma_f32_16x16x32_bf16 v[8:11], v[140:143], v[28:31], v[8:11]
    v_mfma_f32_16x16x32_bf16 v[12:15], v[156:159], v[28:31], v[12:15]
    s_nop 6
    v_cvt_pk_bf16_f32 v128, v8, v9
    v_cvt_pk_bf16_f32 v129, v10, v11
    v_cvt_pk_bf16_f32 v130, v12, v13
    v_cvt_pk_bf16_f32 v131, v14, v15
    v_lshlrev_b32 v8, 16, v128
    v_and_b32 v9, 0xffff0000, v128
    v_lshlrev_b32 v10, 16, v129
    v_and_b32 v11, 0xffff0000, v129
    v_lshlrev_b32 v12, 16, v130
    v_and_b32 v13, 0xffff0000, v130
    v_lshlrev_b32 v14, 16, v131
    v_and_b32 v15, 0xffff0000, v131
    v_mul_f32 v8, 1035273459, v8
    v_mul_f32 v9, 1035273459, v9
    v_mul_f32 v10, 1035273459, v10
    v_mul_f32 v11, 1035273459, v11
    v_mul_f32 v12, 1035273459, v12
    v_mul_f32 v13, 1035273459, v13
    v_mul_f32 v14, 1035273459, v14
    v_mul_f32 v15, 1035273459, v15
    v_cvt_pk_bf16_f32 v128, v8, v9
    v_cvt_pk_bf16_f32 v129, v10, v11
    v_cvt_pk_bf16_f32 v130, v12, v13
    v_cvt_pk_bf16_f32 v131, v14, v15
    v_lshlrev_b32 v8, 16, v128
    v_and_b32 v9, 0xffff0000, v128
    v_lshlrev_b32 v10, 16, v129
    v_and_b32 v11, 0xffff0000, v129
    v_lshlrev_b32 v12, 16, v130
    v_and_b32 v13, 0xffff0000, v130
    v_lshlrev_b32 v14, 16, v131
    v_and_b32 v15, 0xffff0000, v131
    v_max3_f32 v132, v8, v9, v10
    v_max3_f32 v133, v11, v12, v13
    v_max3_f32 v132, v132, v14, v15
    v_max3_f32 v132, v132, v133, v4
    v_mov_b32 v133, v132
    s_nop 1
    v_permlane16_swap_b32 v133, v132
    v_max_f32 v132, v132, v133
    v_mov_b32 v133, v132
    s_nop 1
    v_permlane32_swap_b32 v133, v132
    v_max_f32 v132, v132, v133
    v_sub_f32 v134, v4, v132
    v_mul_f32 v134, s54, v134
    v_exp_f32 v134, v134
    v_mov_b32 v4, v132
    v_mul_f32 v135, s54, v132
    v_fma_f32 v8, v8, s54, -v135
    v_fma_f32 v9, v9, s54, -v135
    v_fma_f32 v10, v10, s54, -v135
    v_fma_f32 v11, v11, s54, -v135
    v_fma_f32 v12, v12, s54, -v135
    v_fma_f32 v13, v13, s54, -v135
    v_fma_f32 v14, v14, s54, -v135
    v_fma_f32 v15, v15, s54, -v135
    v_exp_f32 v8, v8
    v_exp_f32 v9, v9
    v_exp_f32 v10, v10
    v_exp_f32 v11, v11
    v_exp_f32 v12, v12
    v_exp_f32 v13, v13
    v_exp_f32 v14, v14
    v_exp_f32 v15, v15
    v_pk_mul_f32 v[32:33], v[32:33], v[134:135] op_sel_hi:[1,0]
    v_pk_mul_f32 v[34:35], v[34:35], v[134:135] op_sel_hi:[1,0]
    v_pk_mul_f32 v[36:37], v[36:37], v[134:135] op_sel_hi:[1,0]
    v_pk_mul_f32 v[38:39], v[38:39], v[134:135] op_sel_hi:[1,0]
    v_pk_mul_f32 v[40:41], v[40:41], v[134:135] op_sel_hi:[1,0]
    v_pk_mul_f32 v[42:43], v[42:43], v[134:135] op_sel_hi:[1,0]
    v_pk_mul_f32 v[44:45], v[44:45], v[134:135] op_sel_hi:[1,0]
    v_pk_mul_f32 v[46:47], v[46:47], v[134:135] op_sel_hi:[1,0]
    v_pk_mul_f32 v[48:49], v[48:49], v[134:135] op_sel_hi:[1,0]
    v_pk_mul_f32 v[50:51], v[50:51], v[134:135] op_sel_hi:[1,0]
    v_pk_mul_f32 v[52:53], v[52:53], v[134:135] op_sel_hi:[1,0]
    v_pk_mul_f32 v[54:55], v[54:55], v[134:135] op_sel_hi:[1,0]
    v_pk_mul_f32 v[56:57], v[56:57], v[134:135] op_sel_hi:[1,0]
    v_pk_mul_f32 v[58:59], v[58:59], v[134:135] op_sel_hi:[1,0]
    v_pk_mul_f32 v[60:61], v[60:61], v[134:135] op_sel_hi:[1,0]
    v_pk_mul_f32 v[62:63], v[62:63], v[134:135] op_sel_hi:[1,0]
    v_cvt_pk_bf16_f32 v136, v8, v9
    v_cvt_pk_bf16_f32 v137, v10, v11
    v_cvt_pk_bf16_f32 v138, v12, v13
    v_cvt_pk_bf16_f32 v139, v14, v15
    v_add_f32 v8, v8, v9
    v_add_f32 v10, v10, v11
    v_add_f32 v12, v12, v13
    v_add_f32 v14, v14, v15
    v_add_f32 v8, v8, v10
    v_add_f32 v12, v12, v14
    v_add_f32 v8, v8, v12
    v_fma_f32 v5, v5, v134, v8
    s_waitcnt vmcnt(32)
    v_perm_b32 v144, v164, v160, s52
    v_perm_b32 v148, v164, v160, s53
    v_perm_b32 v145, v172, v168, s52
    v_perm_b32 v149, v172, v168, s53
    v_perm_b32 v146, v180, v176, s52
    v_perm_b32 v150, v180, v176, s53
    v_perm_b32 v147, v188, v184, s52
    v_perm_b32 v151, v188, v184, s53
    s_nop 0
    v_mfma_f32_16x16x32_bf16 v[32:35], v[144:147], v[136:139], v[32:35]
    v_mfma_f32_16x16x32_bf16 v[36:39], v[148:151], v[136:139], v[36:39]
    v_perm_b32 v152, v165, v161, s52
    v_perm_b32 v156, v165, v161, s53
    v_perm_b32 v153, v173, v169, s52
    v_perm_b32 v157, v173, v169, s53
    v_perm_b32 v154, v181, v177, s52
    v_perm_b32 v158, v181, v177, s53
    v_perm_b32 v155, v189, v185, s52
    v_perm_b32 v159, v189, v185, s53
    s_nop 0
    v_mfma_f32_16x16x32_bf16 v[40:43], v[152:155], v[136:139], v[40:43]
    v_mfma_f32_16x16x32_bf16 v[44:47], v[156:159], v[136:139], v[44:47]
    v_perm_b32 v144, v166, v162, s52
    v_perm_b32 v148, v166, v162, s53
    v_perm_b32 v145, v174, v170, s52
    v_perm_b32 v149, v174, v170, s53
    v_perm_b32 v146, v182, v178, s52
    v_perm_b32 v150, v182, v178, s53
    v_perm_b32 v147, v190, v186, s52
    v_perm_b32 v151, v190, v186, s53
    s_nop 0
    v_mfma_f32_16x16x32_bf16 v[48:51], v[144:147], v[136:139], v[48:51]
    v_mfma_f32_16x16x32_bf16 v[52:55], v[148:151], v[136:139], v[52:55]
    v_perm_b32 v152, v167, v163, s52
    v_perm_b32 v156, v167, v163, s53
    v_perm_b32 v153, v175, v171, s52
    v_perm_b32 v157, v175, v171, s53
    v_perm_b32 v154, v183, v179, s52
    v_perm_b32 v158, v183, v179, s53
    v_perm_b32 v155, v191, v187, s52
    v_perm_b32 v159, v191, v187, s53
    s_nop 0
    v_mfma_f32_16x16x32_bf16 v[56:59], v[152:155], v[136:139], v[56:59]
    v_mfma_f32_16x16x32_bf16 v[60:63], v[156:159], v[136:139], v[60:63]
    s_waitcnt vmcnt(4)
    buffer_load_dwordx4 v[128:131], v1, s[8:11], s56 offen offset:0 nt
    buffer_load_dwordx4 v[132:135], v1, s[8:11], s56 offen offset:64 nt
    buffer_load_dwordx4 v[136:139], v1, s[8:11], s56 offen offset:128 nt
    buffer_load_dwordx4 v[140:143], v1, s[8:11], s56 offen offset:192 nt
    s_waitcnt vmcnt(4)
    buffer_load_dwordx4 v[160:163], v3, s[12:15], s56 offen offset:0 nt
    buffer_load_dwordx4 v[164:167], v3, s[12:15], s56 offen offset:256 nt
    buffer_load_dwordx4 v[168:171], v3, s[12:15], s56 offen offset:512 nt
    buffer_load_dwordx4 v[172:175], v3, s[12:15], s56 offen offset:768 nt
    s_waitcnt vmcnt(4)
    buffer_load_dwordx4 v[144:147], v1, s[8:11], s61 offen offset:0 nt
    buffer_load_dwordx4 v[148:151], v1, s[8:11], s61 offen offset:64 nt
    buffer_load_dwordx4 v[152:155], v1, s[8:11], s61 offen offset:128 nt
    buffer_load_dwordx4 v[156:159], v1, s[8:11], s61 offen offset:192 nt
    s_waitcnt vmcnt(4)
    buffer_load_dwordx4 v[176:179], v3, s[12:15], s61 offen offset:0 nt
    buffer_load_dwordx4 v[180:183], v3, s[12:15], s61 offen offset:256 nt
    buffer_load_dwordx4 v[184:187], v3, s[12:15], s61 offen offset:512 nt
    buffer_load_dwordx4 v[188:191], v3, s[12:15], s61 offen offset:768 nt
    s_add_u32 s56, s56, 32768
    s_add_u32 s61, s61, 32768
    s_waitcnt vmcnt(36)
    v_mfma_f32_16x16x32_bf16 v[8:11], v[192:195], v[16:19], 0
    v_mfma_f32_16x16x32_bf16 v[12:15], v[208:211], v[16:19], 0
    v_mfma_f32_16x16x32_bf16 v[8:11], v[196:199], v[20:23], v[8:11]
    v_mfma_f32_16x16x32_bf16 v[12:15], v[212:215], v[20:23], v[12:15]
    v_mfma_f32_16x16x32_bf16 v[8:11], v[200:203], v[24:27], v[8:11]
    v_mfma_f32_16x16x32_bf16 v[12:15], v[216:219], v[24:27], v[12:15]
    v_mfma_f32_16x16x32_bf16 v[8:11], v[204:207], v[28:31], v[8:11]
    v_mfma_f32_16x16x32_bf16 v[12:15], v[220:223], v[28:31], v[12:15]
    s_nop 6
    v_cvt_pk_bf16_f32 v192, v8, v9
    v_cvt_pk_bf16_f32 v193, v10, v11
    v_cvt_pk_bf16_f32 v194, v12, v13
    v_cvt_pk_bf16_f32 v195, v14, v15
    v_lshlrev_b32 v8, 16, v192
    v_and_b32 v9, 0xffff0000, v192
    v_lshlrev_b32 v10, 16, v193
    v_and_b32 v11, 0xffff0000, v193
    v_lshlrev_b32 v12, 16, v194
    v_and_b32 v13, 0xffff0000, v194
    v_lshlrev_b32 v14, 16, v195
    v_and_b32 v15, 0xffff0000, v195
    v_mul_f32 v8, 1035273459, v8
    v_mul_f32 v9, 1035273459, v9
    v_mul_f32 v10, 1035273459, v10
    v_mul_f32 v11, 1035273459, v11
    v_mul_f32 v12, 1035273459, v12
    v_mul_f32 v13, 1035273459, v13
    v_mul_f32 v14, 1035273459, v14
    v_mul_f32 v15, 1035273459, v15
    v_cvt_pk_bf16_f32 v192, v8, v9
    v_cvt_pk_bf16_f32 v193, v10, v11
    v_cvt_pk_bf16_f32 v194, v12, v13
    v_cvt_pk_bf16_f32 v195, v14, v15
    v_lshlrev_b32 v8, 16, v192
    v_and_b32 v9, 0xffff0000, v192
    v_lshlrev_b32 v10, 16, v193
    v_and_b32 v11, 0xffff0000, v193
    v_lshlrev_b32 v12, 16, v194
    v_and_b32 v13, 0xffff0000, v194
    v_lshlrev_b32 v14, 16, v195
    v_and_b32 v15, 0xffff0000, v195
    v_max3_f32 v196, v8, v9, v10
    v_max3_f32 v197, v11, v12, v13
    v_max3_f32 v196, v196, v14, v15
    v_max3_f32 v196, v196, v197, v4
    v_mov_b32 v197, v196
    s_nop 1
    v_permlane16_swap_b32 v197, v196
    v_max_f32 v196, v196, v197
    v_mov_b32 v197, v196
    s_nop 1
    v_permlane32_swap_b32 v197, v196
    v_max_f32 v196, v196, v197
    v_sub_f32 v198, v4, v196
    v_mul_f32 v198, s54, v198
    v_exp_f32 v198, v198
    v_mov_b32 v4, v196
    v_mul_f32 v199, s54, v196
    v_fma_f32 v8, v8, s54, -v199
    v_fma_f32 v9, v9, s54, -v199
    v_fma_f32 v10, v10, s54, -v199
    v_fma_f32 v11, v11, s54, -v199
    v_fma_f32 v12, v12, s54, -v199
    v_fma_f32 v13, v13, s54, -v199
    v_fma_f32 v14, v14, s54, -v199
    v_fma_f32 v15, v15, s54, -v199
    v_exp_f32 v8, v8
    v_exp_f32 v9, v9
    v_exp_f32 v10, v10
    v_exp_f32 v11, v11
    v_exp_f32 v12, v12
    v_exp_f32 v13, v13
    v_exp_f32 v14, v14
    v_exp_f32 v15, v15
    v_pk_mul_f32 v[32:33], v[32:33], v[198:199] op_sel_hi:[1,0]
    v_pk_mul_f32 v[34:35], v[34:35], v[198:199] op_sel_hi:[1,0]
    v_pk_mul_f32 v[36:37], v[36:37], v[198:199] op_sel_hi:[1,0]
    v_pk_mul_f32 v[38:39], v[38:39], v[198:199] op_sel_hi:[1,0]
    v_pk_mul_f32 v[40:41], v[40:41], v[198:199] op_sel_hi:[1,0]
    v_pk_mul_f32 v[42:43], v[42:43], v[198:199] op_sel_hi:[1,0]
    v_pk_mul_f32 v[44:45], v[44:45], v[198:199] op_sel_hi:[1,0]
    v_pk_mul_f32 v[46:47], v[46:47], v[198:199] op_sel_hi:[1,0]
    v_pk_mul_f32 v[48:49], v[48:49], v[198:199] op_sel_hi:[1,0]
    v_pk_mul_f32 v[50:51], v[50:51], v[198:199] op_sel_hi:[1,0]
    v_pk_mul_f32 v[52:53], v[52:53], v[198:199] op_sel_hi:[1,0]
    v_pk_mul_f32 v[54:55], v[54:55], v[198:199] op_sel_hi:[1,0]
    v_pk_mul_f32 v[56:57], v[56:57], v[198:199] op_sel_hi:[1,0]
    v_pk_mul_f32 v[58:59], v[58:59], v[198:199] op_sel_hi:[1,0]
    v_pk_mul_f32 v[60:61], v[60:61], v[198:199] op_sel_hi:[1,0]
    v_pk_mul_f32 v[62:63], v[62:63], v[198:199] op_sel_hi:[1,0]
    v_cvt_pk_bf16_f32 v200, v8, v9
    v_cvt_pk_bf16_f32 v201, v10, v11
    v_cvt_pk_bf16_f32 v202, v12, v13
    v_cvt_pk_bf16_f32 v203, v14, v15
    v_add_f32 v8, v8, v9
    v_add_f32 v10, v10, v11
    v_add_f32 v12, v12, v13
    v_add_f32 v14, v14, v15
    v_add_f32 v8, v8, v10
    v_add_f32 v12, v12, v14
    v_add_f32 v8, v8, v12
    v_fma_f32 v5, v5, v198, v8
    s_waitcnt vmcnt(32)
    v_perm_b32 v208, v228, v224, s52
    v_perm_b32 v212, v228, v224, s53
    v_perm_b32 v209, v236, v232, s52
    v_perm_b32 v213, v236, v232, s53
    v_perm_b32 v210, v244, v240, s52
    v_perm_b32 v214, v244, v240, s53
    v_perm_b32 v211, v252, v248, s52
    v_perm_b32 v215, v252, v248, s53
    s_nop 0
    v_mfma_f32_16x16x32_bf16 v[32:35], v[208:211], v[200:203], v[32:35]
    v_mfma_f32_16x16x32_bf16 v[36:39], v[212:215], v[200:203], v[36:39]
    v_perm_b32 v216, v229, v225, s52
    v_perm_b32 v220, v229, v225, s53
    v_perm_b32 v217, v237, v233, s52
    v_perm_b32 v221, v237, v233, s53
    v_perm_b32 v218, v245, v241, s52
    v_perm_b32 v222, v245, v241, s53
    v_perm_b32 v219, v253, v249, s52
    v_perm_b32 v223, v253, v249, s53
    s_nop 0
    v_mfma_f32_16x16x32_bf16 v[40:43], v[216:219], v[200:203], v[40:43]
    v_mfma_f32_16x16x32_bf16 v[44:47], v[220:223], v[200:203], v[44:47]
    v_perm_b32 v208, v230, v226, s52
    v_perm_b32 v212, v230, v226, s53
    v_perm_b32 v209, v238, v234, s52
    v_perm_b32 v213, v238, v234, s53
    v_perm_b32 v210, v246, v242, s52
    v_perm_b32 v214, v246, v242, s53
    v_perm_b32 v211, v254, v250, s52
    v_perm_b32 v215, v254, v250, s53
    s_nop 0
    v_mfma_f32_16x16x32_bf16 v[48:51], v[208:211], v[200:203], v[48:51]
    v_mfma_f32_16x16x32_bf16 v[52:55], v[212:215], v[200:203], v[52:55]
    v_perm_b32 v216, v231, v227, s52
    v_perm_b32 v220, v231, v227, s53
    v_perm_b32 v217, v239, v235, s52
    v_perm_b32 v221, v239, v235, s53
    v_perm_b32 v218, v247, v243, s52
    v_perm_b32 v222, v247, v243, s53
    v_perm_b32 v219, v255, v251, s52
    v_perm_b32 v223, v255, v251, s53
    s_nop 0
    v_mfma_f32_16x16x32_bf16 v[56:59], v[216:219], v[200:203], v[56:59]
    v_mfma_f32_16x16x32_bf16 v[60:63], v[220:223], v[200:203], v[60:63]
    s_waitcnt vmcnt(4)
    buffer_load_dwordx4 v[192:195], v1, s[8:11], s56 offen offset:0 nt
    buffer_load_dwordx4 v[196:199], v1, s[8:11], s56 offen offset:64 nt
    buffer_load_dwordx4 v[200:203], v1, s[8:11], s56 offen offset:128 nt
    buffer_load_dwordx4 v[204:207], v1, s[8:11], s56 offen offset:192 nt
    s_waitcnt vmcnt(4)
    buffer_load_dwordx4 v[224:227], v3, s[12:15], s56 offen offset:0 nt
    buffer_load_dwordx4 v[228:231], v3, s[12:15], s56 offen offset:256 nt
    buffer_load_dwordx4 v[232:235], v3, s[12:15], s56 offen offset:512 nt
    buffer_load_dwordx4 v[236:239], v3, s[12:15], s56 offen offset:768 nt
    s_waitcnt vmcnt(4)
    buffer_load_dwordx4 v[208:211], v1, s[8:11], s61 offen offset:0 nt
    buffer_load_dwordx4 v[212:215], v1, s[8:11], s61 offen offset:64 nt
    buffer_load_dwordx4 v[216:219], v1, s[8:11], s61 offen offset:128 nt
    buffer_load_dwordx4 v[220:223], v1, s[8:11], s61 offen offset:192 nt
    s_waitcnt vmcnt(4)
    buffer_load_dwordx4 v[240:243], v3, s[12:15], s61 offen offset:0 nt
    buffer_load_dwordx4 v[244:247], v3, s[12:15], s61 offen offset:256 nt
    buffer_load_dwordx4 v[248:251], v3, s[12:15], s61 offen offset:512 nt
    buffer_load_dwordx4 v[252:255], v3, s[12:15], s61 offen offset:768 nt
    s_add_u32 s56, s56, 32768
    s_add_u32 s61, s61, 32768
    s_waitcnt vmcnt(36)
    v_mfma_f32_16x16x32_bf16 v[8:11], v[64:67], v[16:19], 0
    v_mfma_f32_16x16x32_bf16 v[12:15], v[80:83], v[16:19], 0
    v_mfma_f32_16x16x32_bf16 v[8:11], v[68:71], v[20:23], v[8:11]
    v_mfma_f32_16x16x32_bf16 v[12:15], v[84:87], v[20:23], v[12:15]
    v_mfma_f32_16x16x32_bf16 v[8:11], v[72:75], v[24:27], v[8:11]
    v_mfma_f32_16x16x32_bf16 v[12:15], v[88:91], v[24:27], v[12:15]
    v_mfma_f32_16x16x32_bf16 v[8:11], v[76:79], v[28:31], v[8:11]
    v_mfma_f32_16x16x32_bf16 v[12:15], v[92:95], v[28:31], v[12:15]
    s_nop 6
    v_cvt_pk_bf16_f32 v64, v8, v9
    v_cvt_pk_bf16_f32 v65, v10, v11
    v_cvt_pk_bf16_f32 v66, v12, v13
    v_cvt_pk_bf16_f32 v67, v14, v15
    v_lshlrev_b32 v8, 16, v64
    v_and_b32 v9, 0xffff0000, v64
    v_lshlrev_b32 v10, 16, v65
    v_and_b32 v11, 0xffff0000, v65
    v_lshlrev_b32 v12, 16, v66
    v_and_b32 v13, 0xffff0000, v66
    v_lshlrev_b32 v14, 16, v67
    v_and_b32 v15, 0xffff0000, v67
    v_mul_f32 v8, 1035273459, v8
    v_mul_f32 v9, 1035273459, v9
    v_mul_f32 v10, 1035273459, v10
    v_mul_f32 v11, 1035273459, v11
    v_mul_f32 v12, 1035273459, v12
    v_mul_f32 v13, 1035273459, v13
    v_mul_f32 v14, 1035273459, v14
    v_mul_f32 v15, 1035273459, v15
    v_cvt_pk_bf16_f32 v64, v8, v9
    v_cvt_pk_bf16_f32 v65, v10, v11
    v_cvt_pk_bf16_f32 v66, v12, v13
    v_cvt_pk_bf16_f32 v67, v14, v15
    v_lshlrev_b32 v8, 16, v64
    v_and_b32 v9, 0xffff0000, v64
    v_lshlrev_b32 v10, 16, v65
    v_and_b32 v11, 0xffff0000, v65
    v_lshlrev_b32 v12, 16, v66
    v_and_b32 v13, 0xffff0000, v66
    v_lshlrev_b32 v14, 16, v67
    v_and_b32 v15, 0xffff0000, v67
    v_max3_f32 v68, v8, v9, v10
    v_max3_f32 v69, v11, v12, v13
    v_max3_f32 v68, v68, v14, v15
    v_max3_f32 v68, v68, v69, v4
    v_mov_b32 v69, v68
    s_nop 1
    v_permlane16_swap_b32 v69, v68
    v_max_f32 v68, v68, v69
    v_mov_b32 v69, v68
    s_nop 1
    v_permlane32_swap_b32 v69, v68
    v_max_f32 v68, v68, v69
    v_sub_f32 v70, v4, v68
    v_mul_f32 v70, s54, v70
    v_exp_f32 v70, v70
    v_mov_b32 v4, v68
    v_mul_f32 v71, s54, v68
    v_fma_f32 v8, v8, s54, -v71
    v_fma_f32 v9, v9, s54, -v71
    v_fma_f32 v10, v10, s54, -v71
    v_fma_f32 v11, v11, s54, -v71
    v_fma_f32 v12, v12, s54, -v71
    v_fma_f32 v13, v13, s54, -v71
    v_fma_f32 v14, v14, s54, -v71
    v_fma_f32 v15, v15, s54, -v71
    v_exp_f32 v8, v8
    v_exp_f32 v9, v9
    v_exp_f32 v10, v10
    v_exp_f32 v11, v11
    v_exp_f32 v12, v12
    v_exp_f32 v13, v13
    v_exp_f32 v14, v14
    v_exp_f32 v15, v15
    v_pk_mul_f32 v[32:33], v[32:33], v[70:71] op_sel_hi:[1,0]
    v_pk_mul_f32 v[34:35], v[34:35], v[70:71] op_sel_hi:[1,0]
    v_pk_mul_f32 v[36:37], v[36:37], v[70:71] op_sel_hi:[1,0]
    v_pk_mul_f32 v[38:39], v[38:39], v[70:71] op_sel_hi:[1,0]
    v_pk_mul_f32 v[40:41], v[40:41], v[70:71] op_sel_hi:[1,0]
    v_pk_mul_f32 v[42:43], v[42:43], v[70:71] op_sel_hi:[1,0]
    v_pk_mul_f32 v[44:45], v[44:45], v[70:71] op_sel_hi:[1,0]
    v_pk_mul_f32 v[46:47], v[46:47], v[70:71] op_sel_hi:[1,0]
    v_pk_mul_f32 v[48:49], v[48:49], v[70:71] op_sel_hi:[1,0]
    v_pk_mul_f32 v[50:51], v[50:51], v[70:71] op_sel_hi:[1,0]
    v_pk_mul_f32 v[52:53], v[52:53], v[70:71] op_sel_hi:[1,0]
    v_pk_mul_f32 v[54:55], v[54:55], v[70:71] op_sel_hi:[1,0]
    v_pk_mul_f32 v[56:57], v[56:57], v[70:71] op_sel_hi:[1,0]
    v_pk_mul_f32 v[58:59], v[58:59], v[70:71] op_sel_hi:[1,0]
    v_pk_mul_f32 v[60:61], v[60:61], v[70:71] op_sel_hi:[1,0]
    v_pk_mul_f32 v[62:63], v[62:63], v[70:71] op_sel_hi:[1,0]
    v_cvt_pk_bf16_f32 v72, v8, v9
    v_cvt_pk_bf16_f32 v73, v10, v11
    v_cvt_pk_bf16_f32 v74, v12, v13
    v_cvt_pk_bf16_f32 v75, v14, v15
    v_add_f32 v8, v8, v9
    v_add_f32 v10, v10, v11
    v_add_f32 v12, v12, v13
    v_add_f32 v14, v14, v15
    v_add_f32 v8, v8, v10
    v_add_f32 v12, v12, v14
    v_add_f32 v8, v8, v12
    v_fma_f32 v5, v5, v70, v8
    s_waitcnt vmcnt(32)
    v_perm_b32 v80, v100, v96, s52
    v_perm_b32 v84, v100, v96, s53
    v_perm_b32 v81, v108, v104, s52
    v_perm_b32 v85, v108, v104, s53
    v_perm_b32 v82, v116, v112, s52
    v_perm_b32 v86, v116, v112, s53
    v_perm_b32 v83, v124, v120, s52
    v_perm_b32 v87, v124, v120, s53
    s_nop 0
    v_mfma_f32_16x16x32_bf16 v[32:35], v[80:83], v[72:75], v[32:35]
    v_mfma_f32_16x16x32_bf16 v[36:39], v[84:87], v[72:75], v[36:39]
    v_perm_b32 v88, v101, v97, s52
    v_perm_b32 v92, v101, v97, s53
    v_perm_b32 v89, v109, v105, s52
    v_perm_b32 v93, v109, v105, s53
    v_perm_b32 v90, v117, v113, s52
    v_perm_b32 v94, v117, v113, s53
    v_perm_b32 v91, v125, v121, s52
    v_perm_b32 v95, v125, v121, s53
    s_nop 0
    v_mfma_f32_16x16x32_bf16 v[40:43], v[88:91], v[72:75], v[40:43]
    v_mfma_f32_16x16x32_bf16 v[44:47], v[92:95], v[72:75], v[44:47]
    v_perm_b32 v80, v102, v98, s52
    v_perm_b32 v84, v102, v98, s53
    v_perm_b32 v81, v110, v106, s52
    v_perm_b32 v85, v110, v106, s53
    v_perm_b32 v82, v118, v114, s52
    v_perm_b32 v86, v118, v114, s53
    v_perm_b32 v83, v126, v122, s52
    v_perm_b32 v87, v126, v122, s53
    s_nop 0
    v_mfma_f32_16x16x32_bf16 v[48:51], v[80:83], v[72:75], v[48:51]
    v_mfma_f32_16x16x32_bf16 v[52:55], v[84:87], v[72:75], v[52:55]
    v_perm_b32 v88, v103, v99, s52
    v_perm_b32 v92, v103, v99, s53
    v_perm_b32 v89, v111, v107, s52
    v_perm_b32 v93, v111, v107, s53
    v_perm_b32 v90, v119, v115, s52
    v_perm_b32 v94, v119, v115, s53
    v_perm_b32 v91, v127, v123, s52
    v_perm_b32 v95, v127, v123, s53
    s_nop 0
    v_mfma_f32_16x16x32_bf16 v[56:59], v[88:91], v[72:75], v[56:59]
    v_mfma_f32_16x16x32_bf16 v[60:63], v[92:95], v[72:75], v[60:63]
    s_waitcnt vmcnt(4)
    buffer_load_dwordx4 v[64:67], v1, s[8:11], s56 offen offset:0 nt
    buffer_load_dwordx4 v[68:71], v1, s[8:11], s56 offen offset:64 nt
    buffer_load_dwordx4 v[72:75], v1, s[8:11], s56 offen offset:128 nt
    buffer_load_dwordx4 v[76:79], v1, s[8:11], s56 offen offset:192 nt
    s_waitcnt vmcnt(4)
    buffer_load_dwordx4 v[96:99], v3, s[12:15], s56 offen offset:0 nt
    buffer_load_dwordx4 v[100:103], v3, s[12:15], s56 offen offset:256 nt
    buffer_load_dwordx4 v[104:107], v3, s[12:15], s56 offen offset:512 nt
    buffer_load_dwordx4 v[108:111], v3, s[12:15], s56 offen offset:768 nt
    s_waitcnt vmcnt(4)
    buffer_load_dwordx4 v[80:83], v1, s[8:11], s61 offen offset:0 nt
    buffer_load_dwordx4 v[84:87], v1, s[8:11], s61 offen offset:64 nt
    buffer_load_dwordx4 v[88:91], v1, s[8:11], s61 offen offset:128 nt
    buffer_load_dwordx4 v[92:95], v1, s[8:11], s61 offen offset:192 nt
    s_waitcnt vmcnt(4)
    buffer_load_dwordx4 v[112:115], v3, s[12:15], s61 offen offset:0 nt
    buffer_load_dwordx4 v[116:119], v3, s[12:15], s61 offen offset:256 nt
    buffer_load_dwordx4 v[120:123], v3, s[12:15], s61 offen offset:512 nt
    buffer_load_dwordx4 v[124:127], v3, s[12:15], s61 offen offset:768 nt
    s_add_u32 s56, s56, 32768
    s_add_u32 s61, s61, 32768
    s_waitcnt vmcnt(36)
    v_mfma_f32_16x16x32_bf16 v[8:11], v[128:131], v[16:19], 0
    v_mfma_f32_16x16x32_bf16 v[12:15], v[144:147], v[16:19], 0
    v_mfma_f32_16x16x32_bf16 v[8:11], v[132:135], v[20:23], v[8:11]
    v_mfma_f32_16x16x32_bf16 v[12:15], v[148:151], v[20:23], v[12:15]
    v_mfma_f32_16x16x32_bf16 v[8:11], v[136:139], v[24:27], v[8:11]
    v_mfma_f32_16x16x32_bf16 v[12:15], v[152:155], v[24:27], v[12:15]
    v_mfma_f32_16x16x32_bf16 v[8:11], v[140:143], v[28:31], v[8:11]
    v_mfma_f32_16x16x32_bf16 v[12:15], v[156:159], v[28:31], v[12:15]
    s_nop 6
    v_cvt_pk_bf16_f32 v128, v8, v9
    v_cvt_pk_bf16_f32 v129, v10, v11
    v_cvt_pk_bf16_f32 v130, v12, v13
    v_cvt_pk_bf16_f32 v131, v14, v15
    v_lshlrev_b32 v8, 16, v128
    v_and_b32 v9, 0xffff0000, v128
    v_lshlrev_b32 v10, 16, v129
    v_and_b32 v11, 0xffff0000, v129
    v_lshlrev_b32 v12, 16, v130
    v_and_b32 v13, 0xffff0000, v130
    v_lshlrev_b32 v14, 16, v131
    v_and_b32 v15, 0xffff0000, v131
    v_mul_f32 v8, 1035273459, v8
    v_mul_f32 v9, 1035273459, v9
    v_mul_f32 v10, 1035273459, v10
    v_mul_f32 v11, 1035273459, v11
    v_mul_f32 v12, 1035273459, v12
    v_mul_f32 v13, 1035273459, v13
    v_mul_f32 v14, 1035273459, v14
    v_mul_f32 v15, 1035273459, v15
    v_cvt_pk_bf16_f32 v128, v8, v9
    v_cvt_pk_bf16_f32 v129, v10, v11
    v_cvt_pk_bf16_f32 v130, v12, v13
    v_cvt_pk_bf16_f32 v131, v14, v15
    v_lshlrev_b32 v8, 16, v128
    v_and_b32 v9, 0xffff0000, v128
    v_lshlrev_b32 v10, 16, v129
    v_and_b32 v11, 0xffff0000, v129
    v_lshlrev_b32 v12, 16, v130
    v_and_b32 v13, 0xffff0000, v130
    v_lshlrev_b32 v14, 16, v131
    v_and_b32 v15, 0xffff0000, v131
    v_max3_f32 v132, v8, v9, v10
    v_max3_f32 v133, v11, v12, v13
    v_max3_f32 v132, v132, v14, v15
    v_max3_f32 v132, v132, v133, v4
    v_mov_b32 v133, v132
    s_nop 1
    v_permlane16_swap_b32 v133, v132
    v_max_f32 v132, v132, v133
    v_mov_b32 v133, v132
    s_nop 1
    v_permlane32_swap_b32 v133, v132
    v_max_f32 v132, v132, v133
    v_sub_f32 v134, v4, v132
    v_mul_f32 v134, s54, v134
    v_exp_f32 v134, v134
    v_mov_b32 v4, v132
    v_mul_f32 v135, s54, v132
    v_fma_f32 v8, v8, s54, -v135
    v_fma_f32 v9, v9, s54, -v135
    v_fma_f32 v10, v10, s54, -v135
    v_fma_f32 v11, v11, s54, -v135
    v_fma_f32 v12, v12, s54, -v135
    v_fma_f32 v13, v13, s54, -v135
    v_fma_f32 v14, v14, s54, -v135
    v_fma_f32 v15, v15, s54, -v135
    v_exp_f32 v8, v8
    v_exp_f32 v9, v9
    v_exp_f32 v10, v10
    v_exp_f32 v11, v11
    v_exp_f32 v12, v12
    v_exp_f32 v13, v13
    v_exp_f32 v14, v14
    v_exp_f32 v15, v15
    v_pk_mul_f32 v[32:33], v[32:33], v[134:135] op_sel_hi:[1,0]
    v_pk_mul_f32 v[34:35], v[34:35], v[134:135] op_sel_hi:[1,0]
    v_pk_mul_f32 v[36:37], v[36:37], v[134:135] op_sel_hi:[1,0]
    v_pk_mul_f32 v[38:39], v[38:39], v[134:135] op_sel_hi:[1,0]
    v_pk_mul_f32 v[40:41], v[40:41], v[134:135] op_sel_hi:[1,0]
    v_pk_mul_f32 v[42:43], v[42:43], v[134:135] op_sel_hi:[1,0]
    v_pk_mul_f32 v[44:45], v[44:45], v[134:135] op_sel_hi:[1,0]
    v_pk_mul_f32 v[46:47], v[46:47], v[134:135] op_sel_hi:[1,0]
    v_pk_mul_f32 v[48:49], v[48:49], v[134:135] op_sel_hi:[1,0]
    v_pk_mul_f32 v[50:51], v[50:51], v[134:135] op_sel_hi:[1,0]
    v_pk_mul_f32 v[52:53], v[52:53], v[134:135] op_sel_hi:[1,0]
    v_pk_mul_f32 v[54:55], v[54:55], v[134:135] op_sel_hi:[1,0]
    v_pk_mul_f32 v[56:57], v[56:57], v[134:135] op_sel_hi:[1,0]
    v_pk_mul_f32 v[58:59], v[58:59], v[134:135] op_sel_hi:[1,0]
    v_pk_mul_f32 v[60:61], v[60:61], v[134:135] op_sel_hi:[1,0]
    v_pk_mul_f32 v[62:63], v[62:63], v[134:135] op_sel_hi:[1,0]
    v_cvt_pk_bf16_f32 v136, v8, v9
    v_cvt_pk_bf16_f32 v137, v10, v11
    v_cvt_pk_bf16_f32 v138, v12, v13
    v_cvt_pk_bf16_f32 v139, v14, v15
    v_add_f32 v8, v8, v9
    v_add_f32 v10, v10, v11
    v_add_f32 v12, v12, v13
    v_add_f32 v14, v14, v15
    v_add_f32 v8, v8, v10
    v_add_f32 v12, v12, v14
    v_add_f32 v8, v8, v12
    v_fma_f32 v5, v5, v134, v8
    s_waitcnt vmcnt(32)
    v_perm_b32 v144, v164, v160, s52
    v_perm_b32 v148, v164, v160, s53
    v_perm_b32 v145, v172, v168, s52
    v_perm_b32 v149, v172, v168, s53
    v_perm_b32 v146, v180, v176, s52
    v_perm_b32 v150, v180, v176, s53
    v_perm_b32 v147, v188, v184, s52
    v_perm_b32 v151, v188, v184, s53
    s_nop 0
    v_mfma_f32_16x16x32_bf16 v[32:35], v[144:147], v[136:139], v[32:35]
    v_mfma_f32_16x16x32_bf16 v[36:39], v[148:151], v[136:139], v[36:39]
    v_perm_b32 v152, v165, v161, s52
    v_perm_b32 v156, v165, v161, s53
    v_perm_b32 v153, v173, v169, s52
    v_perm_b32 v157, v173, v169, s53
    v_perm_b32 v154, v181, v177, s52
    v_perm_b32 v158, v181, v177, s53
    v_perm_b32 v155, v189, v185, s52
    v_perm_b32 v159, v189, v185, s53
    s_nop 0
    v_mfma_f32_16x16x32_bf16 v[40:43], v[152:155], v[136:139], v[40:43]
    v_mfma_f32_16x16x32_bf16 v[44:47], v[156:159], v[136:139], v[44:47]
    v_perm_b32 v144, v166, v162, s52
    v_perm_b32 v148, v166, v162, s53
    v_perm_b32 v145, v174, v170, s52
    v_perm_b32 v149, v174, v170, s53
    v_perm_b32 v146, v182, v178, s52
    v_perm_b32 v150, v182, v178, s53
    v_perm_b32 v147, v190, v186, s52
    v_perm_b32 v151, v190, v186, s53
    s_nop 0
    v_mfma_f32_16x16x32_bf16 v[48:51], v[144:147], v[136:139], v[48:51]
    v_mfma_f32_16x16x32_bf16 v[52:55], v[148:151], v[136:139], v[52:55]
    v_perm_b32 v152, v167, v163, s52
    v_perm_b32 v156, v167, v163, s53
    v_perm_b32 v153, v175, v171, s52
    v_perm_b32 v157, v175, v171, s53
    v_perm_b32 v154, v183, v179, s52
    v_perm_b32 v158, v183, v179, s53
    v_perm_b32 v155, v191, v187, s52
    v_perm_b32 v159, v191, v187, s53
    s_nop 0
    v_mfma_f32_16x16x32_bf16 v[56:59], v[152:155], v[136:139], v[56:59]
    v_mfma_f32_16x16x32_bf16 v[60:63], v[156:159], v[136:139], v[60:63]
    s_waitcnt vmcnt(4)
    buffer_load_dwordx4 v[128:131], v1, s[8:11], s56 offen offset:0 nt
    buffer_load_dwordx4 v[132:135], v1, s[8:11], s56 offen offset:64 nt
    buffer_load_dwordx4 v[136:139], v1, s[8:11], s56 offen offset:128 nt
    buffer_load_dwordx4 v[140:143], v1, s[8:11], s56 offen offset:192 nt
    s_waitcnt vmcnt(4)
    buffer_load_dwordx4 v[144:147], v1, s[8:11], s61 offen offset:0 nt
    buffer_load_dwordx4 v[148:151], v1, s[8:11], s61 offen offset:64 nt
    buffer_load_dwordx4 v[152:155], v1, s[8:11], s61 offen offset:128 nt
    buffer_load_dwordx4 v[156:159], v1, s[8:11], s61 offen offset:192 nt
    s_waitcnt vmcnt(28)
    v_mfma_f32_16x16x32_bf16 v[8:11], v[192:195], v[16:19], 0
    v_mfma_f32_16x16x32_bf16 v[12:15], v[208:211], v[16:19], 0
    v_mfma_f32_16x16x32_bf16 v[8:11], v[196:199], v[20:23], v[8:11]
    v_mfma_f32_16x16x32_bf16 v[12:15], v[212:215], v[20:23], v[12:15]
    v_mfma_f32_16x16x32_bf16 v[8:11], v[200:203], v[24:27], v[8:11]
    v_mfma_f32_16x16x32_bf16 v[12:15], v[216:219], v[24:27], v[12:15]
    v_mfma_f32_16x16x32_bf16 v[8:11], v[204:207], v[28:31], v[8:11]
    v_mfma_f32_16x16x32_bf16 v[12:15], v[220:223], v[28:31], v[12:15]
    s_nop 6
    v_cvt_pk_bf16_f32 v192, v8, v9
    v_cvt_pk_bf16_f32 v193, v10, v11
    v_cvt_pk_bf16_f32 v194, v12, v13
    v_cvt_pk_bf16_f32 v195, v14, v15
    v_lshlrev_b32 v8, 16, v192
    v_and_b32 v9, 0xffff0000, v192
    v_lshlrev_b32 v10, 16, v193
    v_and_b32 v11, 0xffff0000, v193
    v_lshlrev_b32 v12, 16, v194
    v_and_b32 v13, 0xffff0000, v194
    v_lshlrev_b32 v14, 16, v195
    v_and_b32 v15, 0xffff0000, v195
    v_mul_f32 v8, 1035273459, v8
    v_mul_f32 v9, 1035273459, v9
    v_mul_f32 v10, 1035273459, v10
    v_mul_f32 v11, 1035273459, v11
    v_mul_f32 v12, 1035273459, v12
    v_mul_f32 v13, 1035273459, v13
    v_mul_f32 v14, 1035273459, v14
    v_mul_f32 v15, 1035273459, v15
    v_cvt_pk_bf16_f32 v192, v8, v9
    v_cvt_pk_bf16_f32 v193, v10, v11
    v_cvt_pk_bf16_f32 v194, v12, v13
    v_cvt_pk_bf16_f32 v195, v14, v15
    v_lshlrev_b32 v8, 16, v192
    v_and_b32 v9, 0xffff0000, v192
    v_lshlrev_b32 v10, 16, v193
    v_and_b32 v11, 0xffff0000, v193
    v_lshlrev_b32 v12, 16, v194
    v_and_b32 v13, 0xffff0000, v194
    v_lshlrev_b32 v14, 16, v195
    v_and_b32 v15, 0xffff0000, v195
    v_max3_f32 v196, v8, v9, v10
    v_max3_f32 v197, v11, v12, v13
    v_max3_f32 v196, v196, v14, v15
    v_max3_f32 v196, v196, v197, v4
    v_mov_b32 v197, v196
    s_nop 1
    v_permlane16_swap_b32 v197, v196
    v_max_f32 v196, v196, v197
    v_mov_b32 v197, v196
    s_nop 1
    v_permlane32_swap_b32 v197, v196
    v_max_f32 v196, v196, v197
    v_sub_f32 v198, v4, v196
    v_mul_f32 v198, s54, v198
    v_exp_f32 v198, v198
    v_mov_b32 v4, v196
    v_mul_f32 v199, s54, v196
    v_fma_f32 v8, v8, s54, -v199
    v_fma_f32 v9, v9, s54, -v199
    v_fma_f32 v10, v10, s54, -v199
    v_fma_f32 v11, v11, s54, -v199
    v_fma_f32 v12, v12, s54, -v199
    v_fma_f32 v13, v13, s54, -v199
    v_fma_f32 v14, v14, s54, -v199
    v_fma_f32 v15, v15, s54, -v199
    v_exp_f32 v8, v8
    v_exp_f32 v9, v9
    v_exp_f32 v10, v10
    v_exp_f32 v11, v11
    v_exp_f32 v12, v12
    v_exp_f32 v13, v13
    v_exp_f32 v14, v14
    v_exp_f32 v15, v15
    v_pk_mul_f32 v[32:33], v[32:33], v[198:199] op_sel_hi:[1,0]
    v_pk_mul_f32 v[34:35], v[34:35], v[198:199] op_sel_hi:[1,0]
    v_pk_mul_f32 v[36:37], v[36:37], v[198:199] op_sel_hi:[1,0]
    v_pk_mul_f32 v[38:39], v[38:39], v[198:199] op_sel_hi:[1,0]
    v_pk_mul_f32 v[40:41], v[40:41], v[198:199] op_sel_hi:[1,0]
    v_pk_mul_f32 v[42:43], v[42:43], v[198:199] op_sel_hi:[1,0]
    v_pk_mul_f32 v[44:45], v[44:45], v[198:199] op_sel_hi:[1,0]
    v_pk_mul_f32 v[46:47], v[46:47], v[198:199] op_sel_hi:[1,0]
    v_pk_mul_f32 v[48:49], v[48:49], v[198:199] op_sel_hi:[1,0]
    v_pk_mul_f32 v[50:51], v[50:51], v[198:199] op_sel_hi:[1,0]
    v_pk_mul_f32 v[52:53], v[52:53], v[198:199] op_sel_hi:[1,0]
    v_pk_mul_f32 v[54:55], v[54:55], v[198:199] op_sel_hi:[1,0]
    v_pk_mul_f32 v[56:57], v[56:57], v[198:199] op_sel_hi:[1,0]
    v_pk_mul_f32 v[58:59], v[58:59], v[198:199] op_sel_hi:[1,0]
    v_pk_mul_f32 v[60:61], v[60:61], v[198:199] op_sel_hi:[1,0]
    v_pk_mul_f32 v[62:63], v[62:63], v[198:199] op_sel_hi:[1,0]
    v_cvt_pk_bf16_f32 v200, v8, v9
    v_cvt_pk_bf16_f32 v201, v10, v11
    v_cvt_pk_bf16_f32 v202, v12, v13
    v_cvt_pk_bf16_f32 v203, v14, v15
    v_add_f32 v8, v8, v9
    v_add_f32 v10, v10, v11
    v_add_f32 v12, v12, v13
    v_add_f32 v14, v14, v15
    v_add_f32 v8, v8, v10
    v_add_f32 v12, v12, v14
    v_add_f32 v8, v8, v12
    v_fma_f32 v5, v5, v198, v8
    s_waitcnt vmcnt(24)
    v_perm_b32 v208, v228, v224, s52
    v_perm_b32 v212, v228, v224, s53
    v_perm_b32 v209, v236, v232, s52
    v_perm_b32 v213, v236, v232, s53
    v_perm_b32 v210, v244, v240, s52
    v_perm_b32 v214, v244, v240, s53
    v_perm_b32 v211, v252, v248, s52
    v_perm_b32 v215, v252, v248, s53
    s_nop 0
    v_mfma_f32_16x16x32_bf16 v[32:35], v[208:211], v[200:203], v[32:35]
    v_mfma_f32_16x16x32_bf16 v[36:39], v[212:215], v[200:203], v[36:39]
    v_perm_b32 v216, v229, v225, s52
    v_perm_b32 v220, v229, v225, s53
    v_perm_b32 v217, v237, v233, s52
    v_perm_b32 v221, v237, v233, s53
    v_perm_b32 v218, v245, v241, s52
    v_perm_b32 v222, v245, v241, s53
    v_perm_b32 v219, v253, v249, s52
    v_perm_b32 v223, v253, v249, s53
    s_nop 0
    v_mfma_f32_16x16x32_bf16 v[40:43], v[216:219], v[200:203], v[40:43]
    v_mfma_f32_16x16x32_bf16 v[44:47], v[220:223], v[200:203], v[44:47]
    v_perm_b32 v208, v230, v226, s52
    v_perm_b32 v212, v230, v226, s53
    v_perm_b32 v209, v238, v234, s52
    v_perm_b32 v213, v238, v234, s53
    v_perm_b32 v210, v246, v242, s52
    v_perm_b32 v214, v246, v242, s53
    v_perm_b32 v211, v254, v250, s52
    v_perm_b32 v215, v254, v250, s53
    s_nop 0
    v_mfma_f32_16x16x32_bf16 v[48:51], v[208:211], v[200:203], v[48:51]
    v_mfma_f32_16x16x32_bf16 v[52:55], v[212:215], v[200:203], v[52:55]
    v_perm_b32 v216, v231, v227, s52
    v_perm_b32 v220, v231, v227, s53
    v_perm_b32 v217, v239, v235, s52
    v_perm_b32 v221, v239, v235, s53
    v_perm_b32 v218, v247, v243, s52
    v_perm_b32 v222, v247, v243, s53
    v_perm_b32 v219, v255, v251, s52
    v_perm_b32 v223, v255, v251, s53
    s_nop 0
    v_mfma_f32_16x16x32_bf16 v[56:59], v[216:219], v[200:203], v[56:59]
    v_mfma_f32_16x16x32_bf16 v[60:63], v[220:223], v[200:203], v[60:63]
    s_waitcnt vmcnt(4)
    buffer_load_dwordx4 v[160:163], v3, s[12:15], s56 offen offset:0 nt
    buffer_load_dwordx4 v[164:167], v3, s[12:15], s56 offen offset:256 nt
    buffer_load_dwordx4 v[168:171], v3, s[12:15], s56 offen offset:512 nt
    buffer_load_dwordx4 v[172:175], v3, s[12:15], s56 offen offset:768 nt
    s_waitcnt vmcnt(16)
    v_mfma_f32_16x16x32_bf16 v[8:11], v[64:67], v[16:19], 0
    v_mfma_f32_16x16x32_bf16 v[12:15], v[80:83], v[16:19], 0
    v_mfma_f32_16x16x32_bf16 v[8:11], v[68:71], v[20:23], v[8:11]
    v_mfma_f32_16x16x32_bf16 v[12:15], v[84:87], v[20:23], v[12:15]
    v_mfma_f32_16x16x32_bf16 v[8:11], v[72:75], v[24:27], v[8:11]
    v_mfma_f32_16x16x32_bf16 v[12:15], v[88:91], v[24:27], v[12:15]
    v_mfma_f32_16x16x32_bf16 v[8:11], v[76:79], v[28:31], v[8:11]
    v_mfma_f32_16x16x32_bf16 v[12:15], v[92:95], v[28:31], v[12:15]
    s_nop 6
    v_cvt_pk_bf16_f32 v64, v8, v9
    v_cvt_pk_bf16_f32 v65, v10, v11
    v_cvt_pk_bf16_f32 v66, v12, v13
    v_cvt_pk_bf16_f32 v67, v14, v15
    v_lshlrev_b32 v8, 16, v64
    v_and_b32 v9, 0xffff0000, v64
    v_lshlrev_b32 v10, 16, v65
    v_and_b32 v11, 0xffff0000, v65
    v_lshlrev_b32 v12, 16, v66
    v_and_b32 v13, 0xffff0000, v66
    v_lshlrev_b32 v14, 16, v67
    v_and_b32 v15, 0xffff0000, v67
    v_mul_f32 v8, 1035273459, v8
    v_mul_f32 v9, 1035273459, v9
    v_mul_f32 v10, 1035273459, v10
    v_mul_f32 v11, 1035273459, v11
    v_mul_f32 v12, 1035273459, v12
    v_mul_f32 v13, 1035273459, v13
    v_mul_f32 v14, 1035273459, v14
    v_mul_f32 v15, 1035273459, v15
    v_cvt_pk_bf16_f32 v64, v8, v9
    v_cvt_pk_bf16_f32 v65, v10, v11
    v_cvt_pk_bf16_f32 v66, v12, v13
    v_cvt_pk_bf16_f32 v67, v14, v15
    v_lshlrev_b32 v8, 16, v64
    v_and_b32 v9, 0xffff0000, v64
    v_lshlrev_b32 v10, 16, v65
    v_and_b32 v11, 0xffff0000, v65
    v_lshlrev_b32 v12, 16, v66
    v_and_b32 v13, 0xffff0000, v66
    v_lshlrev_b32 v14, 16, v67
    v_and_b32 v15, 0xffff0000, v67
    v_max3_f32 v68, v8, v9, v10
    v_max3_f32 v69, v11, v12, v13
    v_max3_f32 v68, v68, v14, v15
    v_max3_f32 v68, v68, v69, v4
    v_mov_b32 v69, v68
    s_nop 1
    v_permlane16_swap_b32 v69, v68
    v_max_f32 v68, v68, v69
    v_mov_b32 v69, v68
    s_nop 1
    v_permlane32_swap_b32 v69, v68
    v_max_f32 v68, v68, v69
    v_sub_f32 v70, v4, v68
    v_mul_f32 v70, s54, v70
    v_exp_f32 v70, v70
    v_mov_b32 v4, v68
    v_mul_f32 v71, s54, v68
    v_fma_f32 v8, v8, s54, -v71
    v_fma_f32 v9, v9, s54, -v71
    v_fma_f32 v10, v10, s54, -v71
    v_fma_f32 v11, v11, s54, -v71
    v_fma_f32 v12, v12, s54, -v71
    v_fma_f32 v13, v13, s54, -v71
    v_fma_f32 v14, v14, s54, -v71
    v_fma_f32 v15, v15, s54, -v71
    v_exp_f32 v8, v8
    v_exp_f32 v9, v9
    v_exp_f32 v10, v10
    v_exp_f32 v11, v11
    v_exp_f32 v12, v12
    v_exp_f32 v13, v13
    v_exp_f32 v14, v14
    v_exp_f32 v15, v15
    v_pk_mul_f32 v[32:33], v[32:33], v[70:71] op_sel_hi:[1,0]
    v_pk_mul_f32 v[34:35], v[34:35], v[70:71] op_sel_hi:[1,0]
    v_pk_mul_f32 v[36:37], v[36:37], v[70:71] op_sel_hi:[1,0]
    v_pk_mul_f32 v[38:39], v[38:39], v[70:71] op_sel_hi:[1,0]
    v_pk_mul_f32 v[40:41], v[40:41], v[70:71] op_sel_hi:[1,0]
    v_pk_mul_f32 v[42:43], v[42:43], v[70:71] op_sel_hi:[1,0]
    v_pk_mul_f32 v[44:45], v[44:45], v[70:71] op_sel_hi:[1,0]
    v_pk_mul_f32 v[46:47], v[46:47], v[70:71] op_sel_hi:[1,0]
    v_pk_mul_f32 v[48:49], v[48:49], v[70:71] op_sel_hi:[1,0]
    v_pk_mul_f32 v[50:51], v[50:51], v[70:71] op_sel_hi:[1,0]
    v_pk_mul_f32 v[52:53], v[52:53], v[70:71] op_sel_hi:[1,0]
    v_pk_mul_f32 v[54:55], v[54:55], v[70:71] op_sel_hi:[1,0]
    v_pk_mul_f32 v[56:57], v[56:57], v[70:71] op_sel_hi:[1,0]
    v_pk_mul_f32 v[58:59], v[58:59], v[70:71] op_sel_hi:[1,0]
    v_pk_mul_f32 v[60:61], v[60:61], v[70:71] op_sel_hi:[1,0]
    v_pk_mul_f32 v[62:63], v[62:63], v[70:71] op_sel_hi:[1,0]
    v_cvt_pk_bf16_f32 v72, v8, v9
    v_cvt_pk_bf16_f32 v73, v10, v11
    v_cvt_pk_bf16_f32 v74, v12, v13
    v_cvt_pk_bf16_f32 v75, v14, v15
    v_add_f32 v8, v8, v9
    v_add_f32 v10, v10, v11
    v_add_f32 v12, v12, v13
    v_add_f32 v14, v14, v15
    v_add_f32 v8, v8, v10
    v_add_f32 v12, v12, v14
    v_add_f32 v8, v8, v12
    v_fma_f32 v5, v5, v70, v8
    s_waitcnt vmcnt(12)
    v_perm_b32 v80, v100, v96, s52
    v_perm_b32 v84, v100, v96, s53
    v_perm_b32 v81, v108, v104, s52
    v_perm_b32 v85, v108, v104, s53
    v_perm_b32 v82, v116, v112, s52
    v_perm_b32 v86, v116, v112, s53
    v_perm_b32 v83, v124, v120, s52
    v_perm_b32 v87, v124, v120, s53
    s_nop 0
    v_mfma_f32_16x16x32_bf16 v[32:35], v[80:83], v[72:75], v[32:35]
    v_mfma_f32_16x16x32_bf16 v[36:39], v[84:87], v[72:75], v[36:39]
    v_perm_b32 v88, v101, v97, s52
    v_perm_b32 v92, v101, v97, s53
    v_perm_b32 v89, v109, v105, s52
    v_perm_b32 v93, v109, v105, s53
    v_perm_b32 v90, v117, v113, s52
    v_perm_b32 v94, v117, v113, s53
    v_perm_b32 v91, v125, v121, s52
    v_perm_b32 v95, v125, v121, s53
    s_nop 0
    v_mfma_f32_16x16x32_bf16 v[40:43], v[88:91], v[72:75], v[40:43]
    v_mfma_f32_16x16x32_bf16 v[44:47], v[92:95], v[72:75], v[44:47]
    v_perm_b32 v80, v102, v98, s52
    v_perm_b32 v84, v102, v98, s53
    v_perm_b32 v81, v110, v106, s52
    v_perm_b32 v85, v110, v106, s53
    v_perm_b32 v82, v118, v114, s52
    v_perm_b32 v86, v118, v114, s53
    v_perm_b32 v83, v126, v122, s52
    v_perm_b32 v87, v126, v122, s53
    s_nop 0
    v_mfma_f32_16x16x32_bf16 v[48:51], v[80:83], v[72:75], v[48:51]
    v_mfma_f32_16x16x32_bf16 v[52:55], v[84:87], v[72:75], v[52:55]
    v_perm_b32 v88, v103, v99, s52
    v_perm_b32 v92, v103, v99, s53
    v_perm_b32 v89, v111, v107, s52
    v_perm_b32 v93, v111, v107, s53
    v_perm_b32 v90, v119, v115, s52
    v_perm_b32 v94, v119, v115, s53
    v_perm_b32 v91, v127, v123, s52
    v_perm_b32 v95, v127, v123, s53
    s_nop 0
    v_mfma_f32_16x16x32_bf16 v[56:59], v[88:91], v[72:75], v[56:59]
    v_mfma_f32_16x16x32_bf16 v[60:63], v[92:95], v[72:75], v[60:63]
    s_waitcnt vmcnt(4)
    buffer_load_dwordx4 v[176:179], v3, s[12:15], s61 offen offset:0 nt
    buffer_load_dwordx4 v[180:183], v3, s[12:15], s61 offen offset:256 nt
    buffer_load_dwordx4 v[184:187], v3, s[12:15], s61 offen offset:512 nt
    buffer_load_dwordx4 v[188:191], v3, s[12:15], s61 offen offset:768 nt
    s_add_u32 s56, s56, 32768
    s_add_u32 s61, s61, 32768
    s_mov_b64 exec, 1
    ds_add_u32 v6, v7 offset:36
    s_mov_b64 exec, -1
    v_mov_b32 v201, s48
    v_and_b32 v208, 15, v2
    v_lshrrev_b32 v209, 4, v2
    v_lshlrev_b32 v209, 4, v209
    v_mul_u32_u24 v192, 528, v208
    v_add_u32 v192, v192, v209
    s_mul_i32 s27, s3, 4224
    v_add_u32 v192, s27, v192
    v_lshlrev_b32 v193, 3, v208
    s_lshl_b32 s27, s3, 6
    v_add_u32 v193, s27, v193
    v_lshrrev_b32 v208, 5, v2
    s_lshl_b32 s27, s3, 1
    v_add_u32 v208, s27, v208
    v_and_b32 v205, 31, v2
    v_lshlrev_b32 v205, 4, v205
    v_mul_u32_u24 v194, 528, v208
    v_add_u32 v194, v194, v205
    v_lshlrev_b32 v195, 3, v208
    s_lshr_b32 s27, s2, 6
    s_lshl_b32 s27, s27, 3
    v_add_u32 v208, s27, v208
    v_lshlrev_b32 v196, 15, v208
    v_add_u32 v196, v196, v205
    v_lshlrev_b32 v197, 10, v208
    s_and_b32 s27, s2, 63
    s_lshl_b32 s16, s27, 9
    s_add_u32 s16, s16, 1048576
    s_lshl_b32 s17, s27, 4
    s_add_u32 s17, s17, 69632
    s_and_b32 s27, s2, 7
    s_lshl_b32 s27, s27, 2
    s_bfe_u32 s28, s2, 0x20003
    s_add_u32 s27, s27, s28
    s_lshl_b32 s18, s27, 15
    s_lshl_b32 s28, s3, 7
    s_add_u32 s18, s18, s28
    s_add_u32 s18, s18, 1048576
    s_lshl_b32 s19, s27, 10
    s_add_u32 s19, s19, 69632
    s_lshr_b32 s28, s2, 5
    s_lshl_b32 s20, s27, 12
    s_lshl_b32 s28, s28, 9
    s_add_u32 s20, s20, s28
    s_add_u32 s20, s20, 131072
    v_and_b32 v208, 7, v2
    v_lshlrev_b32 v199, 2, v208
    v_lshlrev_b32 v198, 9, v208
    v_lshrrev_b32 v208, 4, v2
    v_lshlrev_b32 v209, 5, v208
    v_add_u32 v198, v198, v209
    v_bfe_u32 v209, v2, 3, 1
    v_lshlrev_b32 v209, 4, v209
    v_add_u32 v198, v198, v209
    v_lshlrev_b32 v200, 4, v2
    v_lshlrev_b32 v202, 5, v2
    s_lshl_b32 s27, s3, 9
    s_add_u32 s27, s27, 4096
    v_add_u32 v202, s27, v202
    s_lshr_b32 s26, s2, 3
    s_and_b32 s28, s2, 7
    s_lshl_b32 s21, s26, 7
    s_lshl_b32 s27, s3, 5
    s_add_u32 s21, s21, s27
    s_lshl_b32 s21, s21, 11
    s_lshl_b32 s27, s28, 8
    s_add_u32 s21, s21, s27
    v_lshlrev_b32 v203, 14, v208
    v_and_b32 v209, 15, v2
    v_lshlrev_b32 v209, 4, v209
    v_add_u32 v203, v203, v209
    v_lshrrev_b32 v209, 5, v2
    v_lshlrev_b32 v209, 13, v209
    v_add_u32 v204, v209, v205
    s_lshl_b32 s22, s26, 14
    s_lshl_b32 s27, s3, 9
    s_add_u32 s22, s22, s27
    s_add_u32 s22, s22, 393216
    s_add_u32 s23, s22, 4096
    s_lshl_b32 s24, s26, 9
    s_add_u32 s24, s24, 102400
    s_lshl_b32 s25, s26, 12
    s_lshl_b32 s27, s28, 9
    s_add_u32 s25, s25, s27
    s_add_u32 s25, s25, 262144
    s_lshl_b32 s27, s3, 7
    v_and_b32 v206, 31, v2
    v_lshlrev_b32 v206, 1, v206
    v_add_u32 v206, s27, v206
    v_lshlrev_b32 v207, 4, v208
    v_add_u32 v207, s27, v207
L_lw_3:
    ds_read_b32 v208, v6 offset:44
    s_waitcnt lgkmcnt(0)
    v_readfirstlane_b32 s79, v208
    s_nop 0
    s_cmp_ge_u32 s79, 4
    s_cbranch_scc0 L_lw_3
    s_lshl_b32 s27, s3, 13
    v_add_u32 v208, s27, v200
    ds_read_b128 v[224:227], v208 offset:31232
    ds_read_b128 v[228:231], v208 offset:32256
    ds_read_b128 v[232:235], v208 offset:33280
    ds_read_b128 v[236:239], v208 offset:34304
    ds_read_b128 v[240:243], v208 offset:35328
    ds_read_b128 v[244:247], v208 offset:36352
    ds_read_b128 v[248:251], v208 offset:37376
    ds_read_b128 v[252:255], v208 offset:38400
    s_waitcnt lgkmcnt(0)
    s_waitcnt vmcnt(8)
    v_mfma_f32_16x16x32_bf16 v[8:11], v[128:131], v[16:19], 0
    v_mfma_f32_16x16x32_bf16 v[12:15], v[144:147], v[16:19], 0
    v_mfma_f32_16x16x32_bf16 v[8:11], v[132:135], v[20:23], v[8:11]
    v_mfma_f32_16x16x32_bf16 v[12:15], v[148:151], v[20:23], v[12:15]
    v_mfma_f32_16x16x32_bf16 v[8:11], v[136:139], v[24:27], v[8:11]
    v_mfma_f32_16x16x32_bf16 v[12:15], v[152:155], v[24:27], v[12:15]
    v_mfma_f32_16x16x32_bf16 v[8:11], v[140:143], v[28:31], v[8:11]
    v_mfma_f32_16x16x32_bf16 v[12:15], v[156:159], v[28:31], v[12:15]
    s_nop 6
    v_cvt_pk_bf16_f32 v128, v8, v9
    v_cvt_pk_bf16_f32 v129, v10, v11
    v_cvt_pk_bf16_f32 v130, v12, v13
    v_cvt_pk_bf16_f32 v131, v14, v15
    v_lshlrev_b32 v8, 16, v128
    v_and_b32 v9, 0xffff0000, v128
    v_lshlrev_b32 v10, 16, v129
    v_and_b32 v11, 0xffff0000, v129
    v_lshlrev_b32 v12, 16, v130
    v_and_b32 v13, 0xffff0000, v130
    v_lshlrev_b32 v14, 16, v131
    v_and_b32 v15, 0xffff0000, v131
    v_mul_f32 v8, 1035273459, v8
    v_mul_f32 v9, 1035273459, v9
    v_mul_f32 v10, 1035273459, v10
    v_mul_f32 v11, 1035273459, v11
    v_mul_f32 v12, 1035273459, v12
    v_mul_f32 v13, 1035273459, v13
    v_mul_f32 v14, 1035273459, v14
    v_mul_f32 v15, 1035273459, v15
    v_cvt_pk_bf16_f32 v128, v8, v9
    v_cvt_pk_bf16_f32 v129, v10, v11
    v_cvt_pk_bf16_f32 v130, v12, v13
    v_cvt_pk_bf16_f32 v131, v14, v15
    v_lshlrev_b32 v8, 16, v128
    v_and_b32 v9, 0xffff0000, v128
    v_lshlrev_b32 v10, 16, v129
    v_and_b32 v11, 0xffff0000, v129
    v_lshlrev_b32 v12, 16, v130
    v_and_b32 v13, 0xffff0000, v130
    v_lshlrev_b32 v14, 16, v131
    v_and_b32 v15, 0xffff0000, v131
    v_max3_f32 v132, v8, v9, v10
    v_max3_f32 v133, v11, v12, v13
    v_max3_f32 v132, v132, v14, v15
    v_max3_f32 v132, v132, v133, v4
    v_mov_b32 v133, v132
    s_nop 1
    v_permlane16_swap_b32 v133, v132
    v_max_f32 v132, v132, v133
    v_mov_b32 v133, v132
    s_nop 1
    v_permlane32_swap_b32 v133, v132
    v_max_f32 v132, v132, v133
    v_sub_f32 v134, v4, v132
    v_mul_f32 v134, s54, v134
    v_exp_f32 v134, v134
    v_mov_b32 v4, v132
    v_mul_f32 v135, s54, v132
    v_fma_f32 v8, v8, s54, -v135
    v_fma_f32 v9, v9, s54, -v135
    v_fma_f32 v10, v10, s54, -v135
    v_fma_f32 v11, v11, s54, -v135
    v_fma_f32 v12, v12, s54, -v135
    v_fma_f32 v13, v13, s54, -v135
    v_fma_f32 v14, v14, s54, -v135
    v_fma_f32 v15, v15, s54, -v135
    v_exp_f32 v8, v8
    v_exp_f32 v9, v9
    v_exp_f32 v10, v10
    v_exp_f32 v11, v11
    v_exp_f32 v12, v12
    v_exp_f32 v13, v13
    v_exp_f32 v14, v14
    v_exp_f32 v15, v15
    v_pk_mul_f32 v[32:33], v[32:33], v[134:135] op_sel_hi:[1,0]
    v_pk_mul_f32 v[34:35], v[34:35], v[134:135] op_sel_hi:[1,0]
    v_pk_mul_f32 v[36:37], v[36:37], v[134:135] op_sel_hi:[1,0]
    v_pk_mul_f32 v[38:39], v[38:39], v[134:135] op_sel_hi:[1,0]
    v_pk_mul_f32 v[40:41], v[40:41], v[134:135] op_sel_hi:[1,0]
    v_pk_mul_f32 v[42:43], v[42:43], v[134:135] op_sel_hi:[1,0]
    v_pk_mul_f32 v[44:45], v[44:45], v[134:135] op_sel_hi:[1,0]
    v_pk_mul_f32 v[46:47], v[46:47], v[134:135] op_sel_hi:[1,0]
    v_pk_mul_f32 v[48:49], v[48:49], v[134:135] op_sel_hi:[1,0]
    v_pk_mul_f32 v[50:51], v[50:51], v[134:135] op_sel_hi:[1,0]
    v_pk_mul_f32 v[52:53], v[52:53], v[134:135] op_sel_hi:[1,0]
    v_pk_mul_f32 v[54:55], v[54:55], v[134:135] op_sel_hi:[1,0]
    v_pk_mul_f32 v[56:57], v[56:57], v[134:135] op_sel_hi:[1,0]
    v_pk_mul_f32 v[58:59], v[58:59], v[134:135] op_sel_hi:[1,0]
    v_pk_mul_f32 v[60:61], v[60:61], v[134:135] op_sel_hi:[1,0]
    v_pk_mul_f32 v[62:63], v[62:63], v[134:135] op_sel_hi:[1,0]
    v_cvt_pk_bf16_f32 v136, v8, v9
    v_cvt_pk_bf16_f32 v137, v10, v11
    v_cvt_pk_bf16_f32 v138, v12, v13
    v_cvt_pk_bf16_f32 v139, v14, v15
    v_add_f32 v8, v8, v9
    v_add_f32 v10, v10, v11
    v_add_f32 v12, v12, v13
    v_add_f32 v14, v14, v15
    v_add_f32 v8, v8, v10
    v_add_f32 v12, v12, v14
    v_add_f32 v8, v8, v12
    v_fma_f32 v5, v5, v134, v8
    s_waitcnt vmcnt(0)
    v_perm_b32 v144, v164, v160, s52
    v_perm_b32 v148, v164, v160, s53
    v_perm_b32 v145, v172, v168, s52
    v_perm_b32 v149, v172, v168, s53
    v_perm_b32 v146, v180, v176, s52
    v_perm_b32 v150, v180, v176, s53
    v_perm_b32 v147, v188, v184, s52
    v_perm_b32 v151, v188, v184, s53
    s_nop 0
    v_mfma_f32_16x16x32_bf16 v[32:35], v[144:147], v[136:139], v[32:35]
    v_mfma_f32_16x16x32_bf16 v[36:39], v[148:151], v[136:139], v[36:39]
    v_perm_b32 v152, v165, v161, s52
    v_perm_b32 v156, v165, v161, s53
    v_perm_b32 v153, v173, v169, s52
    v_perm_b32 v157, v173, v169, s53
    v_perm_b32 v154, v181, v177, s52
    v_perm_b32 v158, v181, v177, s53
    v_perm_b32 v155, v189, v185, s52
    v_perm_b32 v159, v189, v185, s53
    s_nop 0
    v_mfma_f32_16x16x32_bf16 v[40:43], v[152:155], v[136:139], v[40:43]
    v_mfma_f32_16x16x32_bf16 v[44:47], v[156:159], v[136:139], v[44:47]
    v_perm_b32 v144, v166, v162, s52
    v_perm_b32 v148, v166, v162, s53
    v_perm_b32 v145, v174, v170, s52
    v_perm_b32 v149, v174, v170, s53
    v_perm_b32 v146, v182, v178, s52
    v_perm_b32 v150, v182, v178, s53
    v_perm_b32 v147, v190, v186, s52
    v_perm_b32 v151, v190, v186, s53
    s_nop 0
    v_mfma_f32_16x16x32_bf16 v[48:51], v[144:147], v[136:139], v[48:51]
    v_mfma_f32_16x16x32_bf16 v[52:55], v[148:151], v[136:139], v[52:55]
    v_perm_b32 v152, v167, v163, s52
    v_perm_b32 v156, v167, v163, s53
    v_perm_b32 v153, v175, v171, s52
    v_perm_b32 v157, v175, v171, s53
    v_perm_b32 v154, v183, v179, s52
    v_perm_b32 v158, v183, v179, s53
    v_perm_b32 v155, v191, v187, s52
    v_perm_b32 v159, v191, v187, s53
    s_nop 0
    v_mfma_f32_16x16x32_bf16 v[56:59], v[152:155], v[136:139], v[56:59]
    v_mfma_f32_16x16x32_bf16 v[60:63], v[156:159], v[136:139], v[60:63]
    s_mov_b32 exec_lo, 0x00ff00ff
    s_mov_b32 exec_hi, 0x00ff00ff
    ds_write_b128 v192, v[32:35] offset:14336
    ds_write_b128 v192, v[36:39] offset:14400
    ds_write_b128 v192, v[40:43] offset:14464
    ds_write_b128 v192, v[44:47] offset:14528
    ds_write_b128 v192, v[48:51] offset:14592
    ds_write_b128 v192, v[52:55] offset:14656
    ds_write_b128 v192, v[56:59] offset:14720
    ds_write_b128 v192, v[60:63] offset:14784
    s_mov_b64 exec, -1
    v_mov_b32 v9, v5
    s_nop 1
    v_permlane16_swap_b32 v9, v5
    v_add_f32 v5, v5, v9
    v_mov_b32 v9, v5
    s_nop 1
    v_permlane32_swap_b32 v9, v5
    v_add_f32 v5, v5, v9
    s_mov_b64 exec, 0xff
    ds_write_b64 v193, v[4:5] offset:2560
    s_mov_b64 exec, 1
    ds_add_u32 v6, v7 offset:8
    s_mov_b64 exec, -1
L_lw_4:
    ds_read_b32 v15, v6 offset:8
    s_waitcnt lgkmcnt(0)
    v_readfirstlane_b32 s79, v15
    s_nop 0
    s_cmp_ge_u32 s79, 4
    s_cbranch_scc0 L_lw_4
    ds_read_b64 v[80:81], v195 offset:2560
    ds_read_b64 v[82:83], v195 offset:2624
    ds_read_b64 v[84:85], v195 offset:2688
    ds_read_b64 v[86:87], v195 offset:2752
    ds_read_b128 v[64:67], v194 offset:14336
    ds_read_b128 v[68:71], v194 offset:18560
    ds_read_b128 v[72:75], v194 offset:22784
    ds_read_b128 v[76:79], v194 offset:27008
    v_mov_b32 v90, v201
    v_mov_b32 v91, v201
    s_waitcnt lgkmcnt(4)
    v_max3_f32 v88, v80, v82, v84
    v_max_f32 v88, v88, v86
    v_mul_f32 v92, s54, v88
    v_fma_f32 v80, v80, s54, -v92
    v_fma_f32 v82, v82, s54, -v92
    v_fma_f32 v84, v84, s54, -v92
    v_fma_f32 v86, v86, s54, -v92
    v_exp_f32 v80, v80
    v_exp_f32 v82, v82
    v_exp_f32 v84, v84
    v_exp_f32 v86, v86
    v_and_or_b32 v88, v88, s50, v201
    v_mul_f32 v89, v80, v81
    v_fma_f32 v89, v82, v83, v89
    v_fma_f32 v89, v84, v85, v89
    v_fma_f32 v89, v86, v87, v89
    s_waitcnt lgkmcnt(0)
    v_pk_mul_f32 v[96:97], v[64:65], v[80:81] op_sel_hi:[1,0]
    v_pk_mul_f32 v[98:99], v[66:67], v[80:81] op_sel_hi:[1,0]
    v_pk_fma_f32 v[96:97], v[68:69], v[82:83], v[96:97] op_sel_hi:[1,0,1]
    v_pk_fma_f32 v[98:99], v[70:71], v[82:83], v[98:99] op_sel_hi:[1,0,1]
    v_pk_fma_f32 v[96:97], v[72:73], v[84:85], v[96:97] op_sel_hi:[1,0,1]
    v_pk_fma_f32 v[98:99], v[74:75], v[84:85], v[98:99] op_sel_hi:[1,0,1]
    v_pk_fma_f32 v[96:97], v[76:77], v[86:87], v[96:97] op_sel_hi:[1,0,1]
    v_pk_fma_f32 v[98:99], v[78:79], v[86:87], v[98:99] op_sel_hi:[1,0,1]
    v_and_or_b32 v96, v96, s50, v201
    v_and_or_b32 v97, v97, s50, v201
    v_and_or_b32 v98, v98, s50, v201
    v_and_or_b32 v99, v99, s50, v201
    buffer_store_dwordx4 v[96:99], v196, s[36:39], s16 offen sc1
    v_and_or_b32 v89, v89, s50, v201
    s_mov_b32 exec_lo, 1
    s_mov_b32 exec_hi, 1
    buffer_store_dwordx4 v[88:91], v197, s[36:39], s17 offen sc1
    s_mov_b64 exec, -1
    s_cmp_eq_u32 s3, 0
    s_cbranch_scc0 L_notw0_5
    s_sleep 4
    s_mov_b32 s28, 0
    buffer_load_dwordx4 v[116:119], v200, s[36:39], s19 offen sc1
    s_sleep 1
    buffer_load_dwordx4 v[120:123], v200, s[36:39], s19 offen sc1
    s_sleep 1
L_pw_7:
    buffer_load_dwordx4 v[124:127], v200, s[36:39], s19 offen sc1
    s_waitcnt vmcnt(2)
    v_xor_b32 v14, v116, v201
    v_bitop3_b32 v14, v117, v201, v14 bitop3:0xbe
    v_bitop3_b32 v14, v118, v201, v14 bitop3:0xbe
    v_bitop3_b32 v14, v119, v201, v14 bitop3:0xbe
    v_and_b32 v14, 0xff, v14
    v_cmp_ne_u32 vcc, 0, v14
    s_cbranch_vccz L_pwk_9
    s_sleep 1
    buffer_load_dwordx4 v[116:119], v200, s[36:39], s19 offen sc1
    s_waitcnt vmcnt(2)
    v_xor_b32 v14, v120, v201
    v_bitop3_b32 v14, v121, v201, v14 bitop3:0xbe
    v_bitop3_b32 v14, v122, v201, v14 bitop3:0xbe
    v_bitop3_b32 v14, v123, v201, v14 bitop3:0xbe
    v_and_b32 v14, 0xff, v14
    v_cmp_ne_u32 vcc, 0, v14
    s_cbranch_vccz L_pwk_10
    s_sleep 1
    buffer_load_dwordx4 v[120:123], v200, s[36:39], s19 offen sc1
    s_waitcnt vmcnt(2)
    v_xor_b32 v14, v124, v201
    v_bitop3_b32 v14, v125, v201, v14 bitop3:0xbe
    v_bitop3_b32 v14, v126, v201, v14 bitop3:0xbe
    v_bitop3_b32 v14, v127, v201, v14 bitop3:0xbe
    v_and_b32 v14, 0xff, v14
    v_cmp_ne_u32 vcc, 0, v14
    s_cbranch_vccz L_pwk_11
    s_sleep 1
    s_add_u32 s28, s28, 1
    s_cmp_gt_u32 s28, 20000
    s_cbranch_scc0 L_pw_7
L_pwk_9:
    v_xor_b32 v12, v116, v201
    v_xor_b32 v13, v117, v201
    s_branch L_pwd_8
L_pwk_10:
    v_xor_b32 v12, v120, v201
    v_xor_b32 v13, v121, v201
    s_branch L_pwd_8
L_pwk_11:
    v_xor_b32 v12, v124, v201
    v_xor_b32 v13, v125, v201
L_pwd_8:
    s_mov_b64 exec, 1
    ds_add_u32 v6, v7 offset:40
    s_mov_b64 exec, -1
    s_add_u32 s27, s18, 0
    buffer_load_dwordx4 v[64:67], v198, s[36:39], s27 offen sc1
    s_add_u32 s27, s18, 4096
    buffer_load_dwordx4 v[68:71], v198, s[36:39], s27 offen sc1
    s_add_u32 s27, s18, 8192
    buffer_load_dwordx4 v[72:75], v198, s[36:39], s27 offen sc1
    s_add_u32 s27, s18, 12288
    buffer_load_dwordx4 v[76:79], v198, s[36:39], s27 offen sc1
    s_add_u32 s27, s18, 16384
    buffer_load_dwordx4 v[80:83], v198, s[36:39], s27 offen sc1
    s_add_u32 s27, s18, 20480
    buffer_load_dwordx4 v[84:87], v198, s[36:39], s27 offen sc1
    s_add_u32 s27, s18, 24576
    buffer_load_dwordx4 v[88:91], v198, s[36:39], s27 offen sc1
    s_add_u32 s27, s18, 28672
    buffer_load_dwordx4 v[92:95], v198, s[36:39], s27 offen sc1
    v_mov_b32 v14, v12
    s_nop 1
    v_max_f32_dpp v14, v14, v14 row_ror:8 row_mask:0xf bank_mask:0xf
    s_nop 1
    v_max_f32_dpp v14, v14, v14 row_ror:4 row_mask:0xf bank_mask:0xf
    s_nop 1
    v_max_f32_dpp v14, v14, v14 row_ror:2 row_mask:0xf bank_mask:0xf
    s_nop 1
    v_max_f32_dpp v14, v14, v14 row_ror:1 row_mask:0xf bank_mask:0xf
    v_mov_b32 v15, v14
    s_nop 1
    v_permlane16_swap_b32 v15, v14
    v_max_f32 v14, v14, v15
    v_mov_b32 v15, v14
    s_nop 1
    v_permlane32_swap_b32 v15, v14
    v_max_f32 v14, v14, v15
    v_sub_f32 v12, v12, v14
    v_mul_f32 v12, s54, v12
    v_exp_f32 v12, v12
    s_nop 0
    v_mul_f32 v13, v12, v13
    s_nop 1
    v_add_f32_dpp v13, v13, v13 row_ror:8 row_mask:0xf bank_mask:0xf
    s_nop 1
    v_add_f32_dpp v13, v13, v13 row_ror:4 row_mask:0xf bank_mask:0xf
    s_nop 1
    v_add_f32_dpp v13, v13, v13 row_ror:2 row_mask:0xf bank_mask:0xf
    s_nop 1
    v_add_f32_dpp v13, v13, v13 row_ror:1 row_mask:0xf bank_mask:0xf
    v_mov_b32 v15, v13
    s_nop 1
    v_permlane16_swap_b32 v15, v13
    v_add_f32 v13, v13, v15
    v_mov_b32 v15, v13
    s_nop 1
    v_permlane32_swap_b32 v15, v13
    v_add_f32 v13, v13, v15
    v_rcp_f32 v13, v13
    s_nop 0
    v_mul_f32 v12, v12, v13
    v_lshlrev_b32 v14, 2, v2
    ds_write_b32 v14, v12 offset:3584
    s_mov_b64 exec, 1
    ds_add_u32 v6, v7 offset:48
    s_mov_b64 exec, -1
    s_branch L_s2j_6
L_notw0_5:
L_lw_12:
    ds_read_b32 v14, v6 offset:40
    s_waitcnt lgkmcnt(0)
    v_readfirstlane_b32 s79, v14
    s_nop 0
    s_cmp_ge_u32 s79, 1
    s_cbranch_scc0 L_lw_12
    s_add_u32 s27, s18, 0
    buffer_load_dwordx4 v[64:67], v198, s[36:39], s27 offen sc1
    s_add_u32 s27, s18, 4096
    buffer_load_dwordx4 v[68:71], v198, s[36:39], s27 offen sc1
    s_add_u32 s27, s18, 8192
    buffer_load_dwordx4 v[72:75], v198, s[36:39], s27 offen sc1
    s_add_u32 s27, s18, 12288
    buffer_load_dwordx4 v[76:79], v198, s[36:39], s27 offen sc1
    s_add_u32 s27, s18, 16384
    buffer_load_dwordx4 v[80:83], v198, s[36:39], s27 offen sc1
    s_add_u32 s27, s18, 20480
    buffer_load_dwordx4 v[84:87], v198, s[36:39], s27 offen sc1
    s_add_u32 s27, s18, 24576
    buffer_load_dwordx4 v[88:91], v198, s[36:39], s27 offen sc1
    s_add_u32 s27, s18, 28672
    buffer_load_dwordx4 v[92:95], v198, s[36:39], s27 offen sc1
L_s2j_6:
L_lw_13:
    ds_read_b32 v14, v6 offset:48
    s_waitcnt lgkmcnt(0)
    v_readfirstlane_b32 s79, v14
    s_nop 0
    s_cmp_ge_u32 s79, 1
    s_cbranch_scc0 L_lw_13
    ds_read_b32 v96, v199 offset:3584
    ds_read_b32 v97, v199 offset:3616
    ds_read_b32 v98, v199 offset:3648
    ds_read_b32 v99, v199 offset:3680
    ds_read_b32 v100, v199 offset:3712
    ds_read_b32 v101, v199 offset:3744
    ds_read_b32 v102, v199 offset:3776
    ds_read_b32 v103, v199 offset:3808
    s_mov_b32 s78, 0
L_s2re_14:
    s_waitcnt vmcnt(0) lgkmcnt(0)
    v_xor_b32 v64, v64, v201
    v_xor_b32 v65, v65, v201
    v_xor_b32 v66, v66, v201
    v_xor_b32 v67, v67, v201
    v_pk_mul_f32 v[104:105], v[64:65], v[96:97] op_sel_hi:[1,0]
    v_pk_mul_f32 v[106:107], v[66:67], v[96:97] op_sel_hi:[1,0]
    v_xor_b32 v68, v68, v201
    v_xor_b32 v69, v69, v201
    v_xor_b32 v70, v70, v201
    v_xor_b32 v71, v71, v201
    v_pk_fma_f32 v[104:105], v[68:69], v[96:97], v[104:105] op_sel:[0,1,0] op_sel_hi:[1,1,1]
    v_pk_fma_f32 v[106:107], v[70:71], v[96:97], v[106:107] op_sel:[0,1,0] op_sel_hi:[1,1,1]
    v_xor_b32 v72, v72, v201
    v_xor_b32 v73, v73, v201
    v_xor_b32 v74, v74, v201
    v_xor_b32 v75, v75, v201
    v_pk_fma_f32 v[104:105], v[72:73], v[98:99], v[104:105] op_sel_hi:[1,0,1]
    v_pk_fma_f32 v[106:107], v[74:75], v[98:99], v[106:107] op_sel_hi:[1,0,1]
    v_xor_b32 v76, v76, v201
    v_xor_b32 v77, v77, v201
    v_xor_b32 v78, v78, v201
    v_xor_b32 v79, v79, v201
    v_pk_fma_f32 v[104:105], v[76:77], v[98:99], v[104:105] op_sel:[0,1,0] op_sel_hi:[1,1,1]
    v_pk_fma_f32 v[106:107], v[78:79], v[98:99], v[106:107] op_sel:[0,1,0] op_sel_hi:[1,1,1]
    v_xor_b32 v80, v80, v201
    v_xor_b32 v81, v81, v201
    v_xor_b32 v82, v82, v201
    v_xor_b32 v83, v83, v201
    v_pk_fma_f32 v[104:105], v[80:81], v[100:101], v[104:105] op_sel_hi:[1,0,1]
    v_pk_fma_f32 v[106:107], v[82:83], v[100:101], v[106:107] op_sel_hi:[1,0,1]
    v_xor_b32 v84, v84, v201
    v_xor_b32 v85, v85, v201
    v_xor_b32 v86, v86, v201
    v_xor_b32 v87, v87, v201
    v_pk_fma_f32 v[104:105], v[84:85], v[100:101], v[104:105] op_sel:[0,1,0] op_sel_hi:[1,1,1]
    v_pk_fma_f32 v[106:107], v[86:87], v[100:101], v[106:107] op_sel:[0,1,0] op_sel_hi:[1,1,1]
    v_xor_b32 v88, v88, v201
    v_xor_b32 v89, v89, v201
    v_xor_b32 v90, v90, v201
    v_xor_b32 v91, v91, v201
    v_pk_fma_f32 v[104:105], v[88:89], v[102:103], v[104:105] op_sel_hi:[1,0,1]
    v_pk_fma_f32 v[106:107], v[90:91], v[102:103], v[106:107] op_sel_hi:[1,0,1]
    v_xor_b32 v92, v92, v201
    v_xor_b32 v93, v93, v201
    v_xor_b32 v94, v94, v201
    v_xor_b32 v95, v95, v201
    v_pk_fma_f32 v[104:105], v[92:93], v[102:103], v[104:105] op_sel:[0,1,0] op_sel_hi:[1,1,1]
    v_pk_fma_f32 v[106:107], v[94:95], v[102:103], v[106:107] op_sel:[0,1,0] op_sel_hi:[1,1,1]
    v_or_b32 v14, v64, v65
    v_add_f32_dpp v104, v104, v104 quad_perm:[1,0,3,2] row_mask:0xf bank_mask:0xf
    v_add_f32_dpp v105, v105, v105 quad_perm:[1,0,3,2] row_mask:0xf bank_mask:0xf
    v_add_f32_dpp v106, v106, v106 quad_perm:[1,0,3,2] row_mask:0xf bank_mask:0xf
    v_add_f32_dpp v107, v107, v107 quad_perm:[1,0,3,2] row_mask:0xf bank_mask:0xf
    v_or3_b32 v14, v66, v67, v14
    v_or3_b32 v14, v68, v69, v14
    v_or3_b32 v14, v70, v71, v14
    v_or3_b32 v14, v72, v73, v14
    v_or3_b32 v14, v74, v75, v14
    v_add_f32_dpp v104, v104, v104 quad_perm:[2,3,0,1] row_mask:0xf bank_mask:0xf
    v_add_f32_dpp v105, v105, v105 quad_perm:[2,3,0,1] row_mask:0xf bank_mask:0xf
    v_add_f32_dpp v106, v106, v106 quad_perm:[2,3,0,1] row_mask:0xf bank_mask:0xf
    v_add_f32_dpp v107, v107, v107 quad_perm:[2,3,0,1] row_mask:0xf bank_mask:0xf
    v_or3_b32 v14, v76, v77, v14
    v_or3_b32 v14, v78, v79, v14
    v_or3_b32 v14, v80, v81, v14
    v_or3_b32 v14, v82, v83, v14
    v_or3_b32 v14, v84, v85, v14
    v_add_f32_dpp v104, v104, v104 row_half_mirror row_mask:0xf bank_mask:0xf
    v_add_f32_dpp v105, v105, v105 row_half_mirror row_mask:0xf bank_mask:0xf
    v_add_f32_dpp v106, v106, v106 row_half_mirror row_mask:0xf bank_mask:0xf
    v_add_f32_dpp v107, v107, v107 row_half_mirror row_mask:0xf bank_mask:0xf
    v_or3_b32 v14, v86, v87, v14
    v_or3_b32 v14, v88, v89, v14
    v_or3_b32 v14, v90, v91, v14
    v_or3_b32 v14, v92, v93, v14
    v_or3_b32 v14, v94, v95, v14
    v_mov_b32_dpp v108, v104 row_ror:8 row_mask:0xf bank_mask:0xf
    v_mov_b32_dpp v109, v105 row_ror:8 row_mask:0xf bank_mask:0xf
    v_mov_b32_dpp v110, v106 row_ror:8 row_mask:0xf bank_mask:0xf
    v_mov_b32_dpp v111, v107 row_ror:8 row_mask:0xf bank_mask:0xf
    v_and_b32 v14, 0xff, v14
    v_cmp_ne_u32 vcc, 0, v14
    v_cvt_pk_bf16_f32 v112, v104, v105
    v_cvt_pk_bf16_f32 v113, v106, v107
    v_cvt_pk_bf16_f32 v114, v108, v109
    v_cvt_pk_bf16_f32 v115, v110, v111
    s_cbranch_vccz L_s2ok_15
    s_add_u32 s78, s78, 1
    s_cmp_gt_u32 s78, 20000
    s_cbranch_scc1 L_s2ok_15
    s_sleep 1
    s_add_u32 s27, s18, 0
    buffer_load_dwordx4 v[64:67], v198, s[36:39], s27 offen sc1
    s_add_u32 s27, s18, 4096
    buffer_load_dwordx4 v[68:71], v198, s[36:39], s27 offen sc1
    s_add_u32 s27, s18, 8192
    buffer_load_dwordx4 v[72:75], v198, s[36:39], s27 offen sc1
    s_add_u32 s27, s18, 12288
    buffer_load_dwordx4 v[76:79], v198, s[36:39], s27 offen sc1
    s_add_u32 s27, s18, 16384
    buffer_load_dwordx4 v[80:83], v198, s[36:39], s27 offen sc1
    s_add_u32 s27, s18, 20480
    buffer_load_dwordx4 v[84:87], v198, s[36:39], s27 offen sc1
    s_add_u32 s27, s18, 24576
    buffer_load_dwordx4 v[88:91], v198, s[36:39], s27 offen sc1
    s_add_u32 s27, s18, 28672
    buffer_load_dwordx4 v[92:95], v198, s[36:39], s27 offen sc1
    s_branch L_s2re_14
L_s2ok_15:
    s_nop 0
    v_mfma_f32_16x16x32_bf16 v[64:67], v[112:115], v[224:227], 0
    v_mfma_f32_16x16x32_bf16 v[68:71], v[112:115], v[228:231], 0
    v_mfma_f32_16x16x32_bf16 v[72:75], v[112:115], v[232:235], 0
    v_mfma_f32_16x16x32_bf16 v[76:79], v[112:115], v[236:239], 0
    v_mfma_f32_16x16x32_bf16 v[80:83], v[112:115], v[240:243], 0
    v_mfma_f32_16x16x32_bf16 v[84:87], v[112:115], v[244:247], 0
    v_mfma_f32_16x16x32_bf16 v[88:91], v[112:115], v[248:251], 0
    v_mfma_f32_16x16x32_bf16 v[92:95], v[112:115], v[252:255], 0
    s_mov_b64 exec, 0xffff
    s_nop 0
    ds_write2_b32 v202, v64, v68 offset0:0 offset1:1
    s_nop 0
    ds_write2_b32 v202, v72, v76 offset0:2 offset1:3
    s_nop 0
    ds_write2_b32 v202, v80, v84 offset0:4 offset1:5
    s_nop 0
    ds_write2_b32 v202, v88, v92 offset0:6 offset1:7
    s_mov_b64 exec, 1
    ds_add_rtn_u32 v96, v6, v7 offset:16
    s_waitcnt lgkmcnt(0)
    s_mov_b64 exec, -1
    v_readfirstlane_b32 s79, v96
    s_nop 0
    s_cmp_eq_u32 s79, 3
    s_cbranch_scc0 L_rp_16
    s_mov_b64 exec, 0xffffffff
    ds_read_b128 v[96:99], v200 offset:4096
    ds_read_b128 v[100:103], v200 offset:4608
    ds_read_b128 v[104:107], v200 offset:5120
    ds_read_b128 v[108:111], v200 offset:5632
    s_waitcnt lgkmcnt(0)
    v_pk_add_f32 v[96:97], v[96:97], v[100:101]
    v_pk_add_f32 v[104:105], v[104:105], v[108:109]
    v_pk_add_f32 v[98:99], v[98:99], v[102:103]
    v_pk_add_f32 v[106:107], v[106:107], v[110:111]
    v_pk_add_f32 v[96:97], v[96:97], v[104:105]
    v_pk_add_f32 v[98:99], v[98:99], v[106:107]
    v_and_or_b32 v96, v96, s50, v201
    v_and_or_b32 v97, v97, s50, v201
    v_and_or_b32 v98, v98, s50, v201
    v_and_or_b32 v99, v99, s50, v201
    buffer_store_dwordx4 v[96:99], v200, s[36:39], s20 offen sc1
    s_mov_b64 exec, 1
    ds_add_u32 v6, v7 offset:20
    s_mov_b64 exec, -1
L_rp_16:
    s_cmp_ge_u32 s26, 28
    s_cbranch_scc1 L_sexit_17
    buffer_load_dwordx4 v[128:131], v203, s[32:35], s21 offen nt
    s_add_u32 s21, s21, 2048
    buffer_load_dwordx4 v[132:135], v203, s[32:35], s21 offen nt
    s_add_u32 s21, s21, 2048
    buffer_load_dwordx4 v[136:139], v203, s[32:35], s21 offen nt
    s_add_u32 s21, s21, 2048
    buffer_load_dwordx4 v[140:143], v203, s[32:35], s21 offen nt
    s_add_u32 s21, s21, 2048
    buffer_load_dwordx4 v[144:147], v203, s[32:35], s21 offen nt
    s_add_u32 s21, s21, 2048
    buffer_load_dwordx4 v[148:151], v203, s[32:35], s21 offen nt
    s_add_u32 s21, s21, 2048
    buffer_load_dwordx4 v[152:155], v203, s[32:35], s21 offen nt
    s_add_u32 s21, s21, 2048
    buffer_load_dwordx4 v[156:159], v203, s[32:35], s21 offen nt
    s_waitcnt vmcnt(0)
    v_perm_b32 v160, v132, v128, s52
    v_perm_b32 v164, v132, v128, s53
    v_perm_b32 v161, v140, v136, s52
    v_perm_b32 v165, v140, v136, s53
    v_perm_b32 v162, v148, v144, s52
    v_perm_b32 v166, v148, v144, s53
    v_perm_b32 v163, v156, v152, s52
    v_perm_b32 v167, v156, v152, s53
    v_perm_b32 v168, v133, v129, s52
    v_perm_b32 v172, v133, v129, s53
    v_perm_b32 v169, v141, v137, s52
    v_perm_b32 v173, v141, v137, s53
    v_perm_b32 v170, v149, v145, s52
    v_perm_b32 v174, v149, v145, s53
    v_perm_b32 v171, v157, v153, s52
    v_perm_b32 v175, v157, v153, s53
    v_perm_b32 v176, v134, v130, s52
    v_perm_b32 v180, v134, v130, s53
    v_perm_b32 v177, v142, v138, s52
    v_perm_b32 v181, v142, v138, s53
    v_perm_b32 v178, v150, v146, s52
    v_perm_b32 v182, v150, v146, s53
    v_perm_b32 v179, v158, v154, s52
    v_perm_b32 v183, v158, v154, s53
    v_perm_b32 v184, v135, v131, s52
    v_perm_b32 v188, v135, v131, s53
    v_perm_b32 v185, v143, v139, s52
    v_perm_b32 v189, v143, v139, s53
    v_perm_b32 v186, v151, v147, s52
    v_perm_b32 v190, v151, v147, s53
    v_perm_b32 v187, v159, v155, s52
    v_perm_b32 v191, v159, v155, s53
L_lw_18:
    ds_read_b32 v11, v6 offset:28
    s_waitcnt lgkmcnt(0)
    v_readfirstlane_b32 s79, v11
    s_nop 0
    s_cmp_ge_u32 s79, 1
    s_cbranch_scc0 L_lw_18
    s_sleep 14
    buffer_load_dwordx4 v[80:83], v205, s[36:39], s24 offen sc1
    buffer_load_dwordx4 v[64:67], v204, s[36:39], s22 offen offset:0 sc1
    buffer_load_dwordx4 v[68:71], v204, s[36:39], s22 offen offset:2048 sc1
    buffer_load_dwordx4 v[72:75], v204, s[36:39], s23 offen offset:0 sc1
    buffer_load_dwordx4 v[76:79], v204, s[36:39], s23 offen offset:2048 sc1
    s_mov_b32 s78, 0
L_s4re_19:
    s_waitcnt vmcnt(0)
    v_xor_b32 v64, v64, v201
    v_xor_b32 v65, v65, v201
    v_xor_b32 v66, v66, v201
    v_xor_b32 v67, v67, v201
    v_xor_b32 v68, v68, v201
    v_xor_b32 v69, v69, v201
    v_xor_b32 v70, v70, v201
    v_xor_b32 v71, v71, v201
    v_xor_b32 v72, v72, v201
    v_xor_b32 v73, v73, v201
    v_xor_b32 v74, v74, v201
    v_xor_b32 v75, v75, v201
    v_xor_b32 v76, v76, v201
    v_xor_b32 v77, v77, v201
    v_xor_b32 v78, v78, v201
    v_xor_b32 v79, v79, v201
    v_xor_b32 v80, v80, v201
    v_xor_b32 v81, v81, v201
    v_xor_b32 v82, v82, v201
    v_xor_b32 v83, v83, v201
    v_add_f32 v12, v80, v81
    v_add_f32 v13, v82, v83
    v_or3_b32 v14, v64, v65, v66
    v_pk_add_f32 v[84:85], v[64:65], v[68:69]
    v_pk_add_f32 v[88:89], v[72:73], v[76:77]
    v_pk_add_f32 v[86:87], v[66:67], v[70:71]
    v_pk_add_f32 v[90:91], v[74:75], v[78:79]
    v_pk_add_f32 v[84:85], v[84:85], v[88:89]
    v_pk_add_f32 v[86:87], v[86:87], v[90:91]
    v_add_f32_dpp v12, v12, v12 row_ror:8 row_mask:0xf bank_mask:0xf
    v_add_f32_dpp v13, v13, v13 row_ror:8 row_mask:0xf bank_mask:0xf
    v_or3_b32 v14, v67, v68, v14
    v_or3_b32 v14, v69, v70, v14
    v_add_f32_dpp v12, v12, v12 row_ror:4 row_mask:0xf bank_mask:0xf
    v_add_f32_dpp v13, v13, v13 row_ror:4 row_mask:0xf bank_mask:0xf
    v_or3_b32 v14, v71, v72, v14
    v_or3_b32 v14, v73, v74, v14
    v_add_f32_dpp v12, v12, v12 row_ror:2 row_mask:0xf bank_mask:0xf
    v_add_f32_dpp v13, v13, v13 row_ror:2 row_mask:0xf bank_mask:0xf
    v_or3_b32 v14, v75, v76, v14
    v_or3_b32 v14, v77, v78, v14
    v_add_f32_dpp v12, v12, v12 row_ror:1 row_mask:0xf bank_mask:0xf
    v_add_f32_dpp v13, v13, v13 row_ror:1 row_mask:0xf bank_mask:0xf
    v_or3_b32 v14, v79, v80, v14
    v_or3_b32 v14, v81, v82, v14
    v_or_b32 v14, v83, v14
    v_mov_b32 v88, v84
    v_mov_b32 v89, v85
    v_mov_b32 v90, v86
    v_mov_b32 v91, v87
    v_permlane32_swap_b32 v88, v84
    v_permlane32_swap_b32 v89, v85
    v_permlane32_swap_b32 v90, v86
    v_permlane32_swap_b32 v91, v87
    v_add_f32 v84, v84, v88
    v_add_f32 v85, v85, v89
    v_add_f32 v86, v86, v90
    v_add_f32 v87, v87, v91
    v_mov_b32 v88, v12
    v_mov_b32 v89, v13
    s_nop 0
    v_permlane16_swap_b32 v88, v12
    v_permlane16_swap_b32 v89, v13
    v_add_f32 v12, v12, v88
    v_add_f32 v13, v13, v89
    v_and_b32 v14, 0xff, v14
    v_cmp_ne_u32 vcc, 0, v14
    v_mul_f32 v12, 0x3a800000, v12
    v_mul_f32 v13, 0x3a800000, v13
    v_fma_f32 v13, -v12, v12, v13
    s_cbranch_vccz L_s4ok_20
    s_add_u32 s78, s78, 1
    s_cmp_gt_u32 s78, 20000
    s_cbranch_scc1 L_s4ok_20
    s_sleep 1
    buffer_load_dwordx4 v[80:83], v205, s[36:39], s24 offen sc1
    buffer_load_dwordx4 v[64:67], v204, s[36:39], s22 offen offset:0 sc1
    buffer_load_dwordx4 v[68:71], v204, s[36:39], s22 offen offset:2048 sc1
    buffer_load_dwordx4 v[72:75], v204, s[36:39], s23 offen offset:0 sc1
    buffer_load_dwordx4 v[76:79], v204, s[36:39], s23 offen offset:2048 sc1
    s_branch L_s4re_19
L_s4ok_20:
    v_max_f32 v13, 0, v13
    v_cvt_pk_bf16_f32 v14, v12, v13
    v_lshlrev_b32 v96, 16, v14
    v_and_b32 v97, 0xffff0000, v14
    v_add_f32 v97, 925353388, v97
    v_cvt_pk_bf16_f32 v14, v97, v97
    v_lshlrev_b32 v97, 16, v14
    v_sqrt_f32 v97, v97
    s_nop 0
    v_cvt_pk_bf16_f32 v14, v97, v97
    v_lshlrev_b32 v97, 16, v14
    v_rcp_f32 v98, v97
    v_fma_f32 v84, -v96, v85, v84
    v_fma_f32 v86, -v96, v87, v86
    v_mul_f32 v84, v84, v98
    v_mul_f32 v86, v86, v98
    v_cvt_pk_bf16_f32 v14, v84, v86
    v_lshlrev_b32 v84, 16, v14
    v_and_b32 v86, 0xffff0000, v14
    v_mul_f32 v12, v84, v84
    v_mul_f32 v12, 0x3d372713, v12
    v_fma_f32 v12, v12, v84, v84
    v_mul_f32 v12, 0xc0135761, v12
    v_exp_f32 v12, v12
    s_nop 0
    v_add_f32 v12, 1.0, v12
    v_rcp_f32 v12, v12
    s_nop 0
    v_mul_f32 v12, v12, v84
    v_cvt_pk_bf16_f32 v12, v12, v12
    v_lshlrev_b32 v12, 16, v12
    v_mul_f32 v12, v12, v86
    v_cvt_pk_bf16_f32 v12, v12, v12
    ds_write_b16 v206, v12 offset:2816
    ds_read_b128 v[100:103], v207 offset:2816
    s_waitcnt lgkmcnt(0)
    v_mfma_f32_16x16x32_bf16 v[64:67], v[100:103], v[160:163], 0
    v_mfma_f32_16x16x32_bf16 v[68:71], v[100:103], v[164:167], 0
    v_mfma_f32_16x16x32_bf16 v[72:75], v[100:103], v[168:171], 0
    v_mfma_f32_16x16x32_bf16 v[76:79], v[100:103], v[172:175], 0
    v_mfma_f32_16x16x32_bf16 v[80:83], v[100:103], v[176:179], 0
    v_mfma_f32_16x16x32_bf16 v[84:87], v[100:103], v[180:183], 0
    v_mfma_f32_16x16x32_bf16 v[88:91], v[100:103], v[184:187], 0
    v_mfma_f32_16x16x32_bf16 v[92:95], v[100:103], v[188:191], 0
    s_mov_b64 exec, 0xffff
    s_nop 0
    ds_write2_b32 v202, v64, v68 offset0:0 offset1:1
    s_nop 0
    ds_write2_b32 v202, v72, v76 offset0:2 offset1:3
    s_nop 0
    ds_write2_b32 v202, v80, v84 offset0:4 offset1:5
    s_nop 0
    ds_write2_b32 v202, v88, v92 offset0:6 offset1:7
    s_mov_b64 exec, 1
    ds_add_rtn_u32 v104, v6, v7 offset:32
    s_waitcnt lgkmcnt(0)
    s_mov_b64 exec, -1
    v_readfirstlane_b32 s79, v104
    s_nop 0
    s_cmp_eq_u32 s79, 3
    s_cbranch_scc0 L_rp_21
    s_mov_b64 exec, 0xffffffff
    ds_read_b128 v[104:107], v200 offset:4096
    ds_read_b128 v[108:111], v200 offset:4608
    ds_read_b128 v[112:115], v200 offset:5120
    ds_read_b128 v[116:119], v200 offset:5632
    s_waitcnt lgkmcnt(0)
    v_pk_add_f32 v[104:105], v[104:105], v[108:109]
    v_pk_add_f32 v[112:113], v[112:113], v[116:117]
    v_pk_add_f32 v[106:107], v[106:107], v[110:111]
    v_pk_add_f32 v[114:115], v[114:115], v[118:119]
    v_pk_add_f32 v[104:105], v[104:105], v[112:113]
    v_pk_add_f32 v[106:107], v[106:107], v[114:115]
    v_and_or_b32 v104, v104, s50, v201
    v_and_or_b32 v105, v105, s50, v201
    v_and_or_b32 v106, v106, s50, v201
    v_and_or_b32 v107, v107, s50, v201
    buffer_store_dwordx4 v[104:107], v200, s[36:39], s25 offen sc1
    s_mov_b64 exec, -1
L_rp_21:
L_sexit_17:
    s_endpgm
L_helper:
    s_setprio 3
    s_sub_u32 s3, s3, 4
    s_lshr_b32 s56, s2, 6
    s_and_b32 s57, s2, 15
    s_bfe_u32 s58, s2, 0x20004
    s_lshl_b32 s60, s58, 8
    s_lshl_b32 s59, s3, 6
    s_add_u32 s60, s60, s59
    s_lshl_b32 s59, s60, 13
    s_lshl_b32 s61, s56, 11
    s_add_u32 s59, s59, s61
    s_lshl_b32 s61, s57, 7
    s_add_u32 s59, s59, s61
    v_and_b32 v9, 7, v2
    v_lshlrev_b32 v9, 4, v9
    v_bfe_u32 v10, v2, 3, 1
    v_lshlrev_b32 v10, 5, v10
    v_lshrrev_b32 v11, 4, v2
    v_lshlrev_b32 v11, 3, v11
    v_add_u32 v12, v10, v11
    v_lshlrev_b32 v12, 13, v12
    v_add_u32 v12, v12, v9
    s_waitcnt lgkmcnt(0)
    v_lshlrev_b32 v13, 5, v2
    buffer_load_dwordx4 v[16:19], v13, s[40:43], 0 offen
    buffer_load_dwordx4 v[20:23], v13, s[40:43], 0 offen offset:16
    v_and_b32 v14, 1, v2
    v_lshlrev_b32 v14, 5, v14
    v_add_u32 v14, v14, v11
    v_add_u32 v14, s60, v14
    v_lshlrev_b32 v14, 1, v14
    buffer_load_dwordx4 v[24:27], v14, s[40:43], 0 offen
    buffer_load_dwordx4 v[64:67], v12, s[16:19], s59 offen nt
    s_add_u32 s59, s59, 8192
    buffer_load_dwordx4 v[68:71], v12, s[16:19], s59 offen nt
    s_add_u32 s59, s59, 8192
    buffer_load_dwordx4 v[72:75], v12, s[16:19], s59 offen nt
    s_add_u32 s59, s59, 8192
    buffer_load_dwordx4 v[76:79], v12, s[16:19], s59 offen nt
    s_add_u32 s59, s59, 8192
    buffer_load_dwordx4 v[80:83], v12, s[16:19], s59 offen nt
    s_add_u32 s59, s59, 8192
    buffer_load_dwordx4 v[84:87], v12, s[16:19], s59 offen nt
    s_add_u32 s59, s59, 8192
    buffer_load_dwordx4 v[88:91], v12, s[16:19], s59 offen nt
    s_add_u32 s59, s59, 8192
    buffer_load_dwordx4 v[92:95], v12, s[16:19], s59 offen nt
    s_barrier
    v_mov_b32 v6, 0
    v_mov_b32 v7, 1
    s_load_dword s49, s[36:37], 0
    s_mov_b32 s50, 0xffffff00
    s_waitcnt lgkmcnt(0)
    s_add_u32 s49, s49, 1
    s_and_b32 s48, s49, 0xff
    v_mov_b32 v8, s48
    s_load_dwordx2 s[24:25], s[0:1], 48
    s_mov_b32 s26, 7340032
    s_mov_b32 s27, 0x20000
    s_load_dwordx2 s[28:29], s[0:1], 56
    s_mov_b32 s30, 7340032
    s_mov_b32 s31, 0x20000
    s_load_dwordx2 s[44:45], s[0:1], 72
    s_mov_b32 s46, 2048
    s_mov_b32 s47, 0x20000
    s_waitcnt vmcnt(8)
    v_lshlrev_b32 v32, 16, v16
    v_and_b32 v33, 0xffff0000, v16
    v_lshlrev_b32 v34, 16, v17
    v_and_b32 v35, 0xffff0000, v17
    v_lshlrev_b32 v36, 16, v18
    v_and_b32 v37, 0xffff0000, v18
    v_lshlrev_b32 v38, 16, v19
    v_and_b32 v39, 0xffff0000, v19
    v_lshlrev_b32 v40, 16, v20
    v_and_b32 v41, 0xffff0000, v20
    v_lshlrev_b32 v42, 16, v21
    v_and_b32 v43, 0xffff0000, v21
    v_lshlrev_b32 v44, 16, v22
    v_and_b32 v45, 0xffff0000, v22
    v_lshlrev_b32 v46, 16, v23
    v_and_b32 v47, 0xffff0000, v23
    v_add_f32 v28, v32, v33
    v_add_f32 v28, v28, v34
    v_add_f32 v28, v28, v35
    v_add_f32 v28, v28, v36
    v_add_f32 v28, v28, v37
    v_add_f32 v28, v28, v38
    v_add_f32 v28, v28, v39
    v_add_f32 v28, v28, v40
    v_add_f32 v28, v28, v41
    v_add_f32 v28, v28, v42
    v_add_f32 v28, v28, v43
    v_add_f32 v28, v28, v44
    v_add_f32 v28, v28, v45
    v_add_f32 v28, v28, v46
    v_add_f32 v28, v28, v47
    s_nop 1
    v_add_f32_dpp v28, v28, v28 row_ror:8 row_mask:0xf bank_mask:0xf
    s_nop 1
    v_add_f32_dpp v28, v28, v28 row_ror:4 row_mask:0xf bank_mask:0xf
    s_nop 1
    v_add_f32_dpp v28, v28, v28 row_ror:2 row_mask:0xf bank_mask:0xf
    s_nop 1
    v_add_f32_dpp v28, v28, v28 row_ror:1 row_mask:0xf bank_mask:0xf
    v_mov_b32 v29, v28
    s_nop 1
    v_permlane16_swap_b32 v29, v28
    v_add_f32 v28, v28, v29
    v_mov_b32 v29, v28
    s_nop 1
    v_permlane32_swap_b32 v29, v28
    v_add_f32 v28, v28, v29
    v_mul_f32 v28, 0x3a800000, v28
    v_sub_f32 v32, v32, v28
    v_sub_f32 v33, v33, v28
    v_sub_f32 v34, v34, v28
    v_sub_f32 v35, v35, v28
    v_sub_f32 v36, v36, v28
    v_sub_f32 v37, v37, v28
    v_sub_f32 v38, v38, v28
    v_sub_f32 v39, v39, v28
    v_sub_f32 v40, v40, v28
    v_sub_f32 v41, v41, v28
    v_sub_f32 v42, v42, v28
    v_sub_f32 v43, v43, v28
    v_sub_f32 v44, v44, v28
    v_sub_f32 v45, v45, v28
    v_sub_f32 v46, v46, v28
    v_sub_f32 v47, v47, v28
    v_mul_f32 v30, v32, v32
    v_fma_f32 v30, v33, v33, v30
    v_fma_f32 v30, v34, v34, v30
    v_fma_f32 v30, v35, v35, v30
    v_fma_f32 v30, v36, v36, v30
    v_fma_f32 v30, v37, v37, v30
    v_fma_f32 v30, v38, v38, v30
    v_fma_f32 v30, v39, v39, v30
    v_fma_f32 v30, v40, v40, v30
    v_fma_f32 v30, v41, v41, v30
    v_fma_f32 v30, v42, v42, v30
    v_fma_f32 v30, v43, v43, v30
    v_fma_f32 v30, v44, v44, v30
    v_fma_f32 v30, v45, v45, v30
    v_fma_f32 v30, v46, v46, v30
    v_fma_f32 v30, v47, v47, v30
    s_nop 1
    v_add_f32_dpp v30, v30, v30 row_ror:8 row_mask:0xf bank_mask:0xf
    s_nop 1
    v_add_f32_dpp v30, v30, v30 row_ror:4 row_mask:0xf bank_mask:0xf
    s_nop 1
    v_add_f32_dpp v30, v30, v30 row_ror:2 row_mask:0xf bank_mask:0xf
    s_nop 1
    v_add_f32_dpp v30, v30, v30 row_ror:1 row_mask:0xf bank_mask:0xf
    v_mov_b32 v29, v30
    s_nop 1
    v_permlane16_swap_b32 v29, v30
    v_add_f32 v30, v30, v29
    v_mov_b32 v29, v30
    s_nop 1
    v_permlane32_swap_b32 v29, v30
    v_add_f32 v30, v30, v29
    v_mul_f32 v30, 0x3a800000, v30
    v_cvt_pk_bf16_f32 v29, v28, v30
    v_lshlrev_b32 v48, 16, v29
    v_and_b32 v49, 0xffff0000, v29
    v_add_f32 v49, 925353388, v49
    v_cvt_pk_bf16_f32 v29, v49, v49
    v_lshlrev_b32 v49, 16, v29
    v_sqrt_f32 v49, v49
    s_nop 0
    v_cvt_pk_bf16_f32 v29, v49, v49
    v_lshlrev_b32 v49, 16, v29
    v_rcp_f32 v50, v49
    v_lshlrev_b32 v52, 16, v24
    v_and_b32 v53, 0xffff0000, v24
    v_lshlrev_b32 v54, 16, v25
    v_and_b32 v55, 0xffff0000, v25
    v_lshlrev_b32 v56, 16, v26
    v_and_b32 v57, 0xffff0000, v26
    v_lshlrev_b32 v58, 16, v27
    v_and_b32 v59, 0xffff0000, v27
    v_sub_f32 v52, v52, v48
    v_sub_f32 v53, v53, v48
    v_sub_f32 v54, v54, v48
    v_sub_f32 v55, v55, v48
    v_sub_f32 v56, v56, v48
    v_sub_f32 v57, v57, v48
    v_sub_f32 v58, v58, v48
    v_sub_f32 v59, v59, v48
    v_cvt_pk_bf16_f32 v29, v52, v53
    v_and_b32 v53, 0xffff0000, v29
    v_lshlrev_b32 v52, 16, v29
    v_cvt_pk_bf16_f32 v29, v54, v55
    v_and_b32 v55, 0xffff0000, v29
    v_lshlrev_b32 v54, 16, v29
    v_cvt_pk_bf16_f32 v29, v56, v57
    v_and_b32 v57, 0xffff0000, v29
    v_lshlrev_b32 v56, 16, v29
    v_cvt_pk_bf16_f32 v29, v58, v59
    v_and_b32 v59, 0xffff0000, v29
    v_lshlrev_b32 v58, 16, v29
    v_mul_f32 v29, v52, v50
    v_fma_f32 v52, -v29, v49, v52
    v_fma_f32 v52, v52, v50, v29
    v_mul_f32 v29, v53, v50
    v_fma_f32 v53, -v29, v49, v53
    v_fma_f32 v53, v53, v50, v29
    v_mul_f32 v29, v54, v50
    v_fma_f32 v54, -v29, v49, v54
    v_fma_f32 v54, v54, v50, v29
    v_mul_f32 v29, v55, v50
    v_fma_f32 v55, -v29, v49, v55
    v_fma_f32 v55, v55, v50, v29
    v_mul_f32 v29, v56, v50
    v_fma_f32 v56, -v29, v49, v56
    v_fma_f32 v56, v56, v50, v29
    v_mul_f32 v29, v57, v50
    v_fma_f32 v57, -v29, v49, v57
    v_fma_f32 v57, v57, v50, v29
    v_mul_f32 v29, v58, v50
    v_fma_f32 v58, -v29, v49, v58
    v_fma_f32 v58, v58, v50, v29
    v_mul_f32 v29, v59, v50
    v_fma_f32 v59, -v29, v49, v59
    v_fma_f32 v59, v59, v50, v29
    v_cvt_pk_bf16_f32 v60, v52, v53
    v_cvt_pk_bf16_f32 v61, v54, v55
    v_cvt_pk_bf16_f32 v62, v56, v57
    v_cvt_pk_bf16_f32 v63, v58, v59
    s_waitcnt vmcnt(0)
    v_perm_b32 v96, v68, v64, s52
    v_perm_b32 v100, v68, v64, s53
    v_perm_b32 v97, v76, v72, s52
    v_perm_b32 v101, v76, v72, s53
    v_perm_b32 v98, v84, v80, s52
    v_perm_b32 v102, v84, v80, s53
    v_perm_b32 v99, v92, v88, s52
    v_perm_b32 v103, v92, v88, s53
    v_perm_b32 v104, v69, v65, s52
    v_perm_b32 v108, v69, v65, s53
    v_perm_b32 v105, v77, v73, s52
    v_perm_b32 v109, v77, v73, s53
    v_perm_b32 v106, v85, v81, s52
    v_perm_b32 v110, v85, v81, s53
    v_perm_b32 v107, v93, v89, s52
    v_perm_b32 v111, v93, v89, s53
    v_perm_b32 v112, v70, v66, s52
    v_perm_b32 v116, v70, v66, s53
    v_perm_b32 v113, v78, v74, s52
    v_perm_b32 v117, v78, v74, s53
    v_perm_b32 v114, v86, v82, s52
    v_perm_b32 v118, v86, v82, s53
    v_perm_b32 v115, v94, v90, s52
    v_perm_b32 v119, v94, v90, s53
    v_perm_b32 v120, v71, v67, s52
    v_perm_b32 v124, v71, v67, s53
    v_perm_b32 v121, v79, v75, s52
    v_perm_b32 v125, v79, v75, s53
    v_perm_b32 v122, v87, v83, s52
    v_perm_b32 v126, v87, v83, s53
    v_perm_b32 v123, v95, v91, s52
    v_perm_b32 v127, v95, v91, s53
    v_mfma_f32_16x16x32_bf16 v[128:131], v[60:63], v[96:99], 0
    v_mfma_f32_16x16x32_bf16 v[132:135], v[60:63], v[100:103], 0
    v_mfma_f32_16x16x32_bf16 v[136:139], v[60:63], v[104:107], 0
    v_mfma_f32_16x16x32_bf16 v[140:143], v[60:63], v[108:111], 0
    v_mfma_f32_16x16x32_bf16 v[144:147], v[60:63], v[112:115], 0
    v_mfma_f32_16x16x32_bf16 v[148:151], v[60:63], v[116:119], 0
    v_mfma_f32_16x16x32_bf16 v[152:155], v[60:63], v[120:123], 0
    v_mfma_f32_16x16x32_bf16 v[156:159], v[60:63], v[124:127], 0
    s_nop 0
    v_add_f32_dpp v160, v129, v128 row_ror:8 row_mask:0xf bank_mask:0xf
    v_add_f32_dpp v161, v133, v132 row_ror:8 row_mask:0xf bank_mask:0xf
    v_add_f32_dpp v162, v137, v136 row_ror:8 row_mask:0xf bank_mask:0xf
    v_add_f32_dpp v163, v141, v140 row_ror:8 row_mask:0xf bank_mask:0xf
    v_add_f32_dpp v164, v145, v144 row_ror:8 row_mask:0xf bank_mask:0xf
    v_add_f32_dpp v165, v149, v148 row_ror:8 row_mask:0xf bank_mask:0xf
    v_add_f32_dpp v166, v153, v152 row_ror:8 row_mask:0xf bank_mask:0xf
    v_add_f32_dpp v167, v157, v156 row_ror:8 row_mask:0xf bank_mask:0xf
    v_lshlrev_b32 v13, 5, v2
    s_lshl_b32 s62, s3, 8
    v_add_u32 v13, s62, v13
    s_mov_b64 exec, 0xff
    ds_write_b128 v13, v[160:163] offset:4096
    ds_write_b128 v13, v[164:167] offset:4112
    s_mov_b64 exec, -1
    s_mov_b64 exec, 1
    ds_add_rtn_u32 v29, v6, v7 offset:0
    s_waitcnt lgkmcnt(0)
    s_mov_b64 exec, -1
    v_readfirstlane_b32 s62, v29
    s_nop 0
    s_cmp_eq_u32 s62, 3
    s_cbranch_scc0 L_qpub_22
    v_lshlrev_b32 v13, 4, v2
    s_mov_b64 exec, 0xffff
    ds_read_b128 v[128:131], v13 offset:4096
    ds_read_b128 v[132:135], v13 offset:4352
    ds_read_b128 v[136:139], v13 offset:4608
    ds_read_b128 v[140:143], v13 offset:4864
    s_waitcnt lgkmcnt(0)
    v_add_f32 v128, v128, v132
    v_add_f32 v136, v136, v140
    v_add_f32 v129, v129, v133
    v_add_f32 v137, v137, v141
    v_add_f32 v130, v130, v134
    v_add_f32 v138, v138, v142
    v_add_f32 v131, v131, v135
    v_add_f32 v139, v139, v143
    v_add_f32 v128, v128, v136
    v_add_f32 v129, v129, v137
    v_add_f32 v130, v130, v138
    v_add_f32 v131, v131, v139
    v_add_u32 v128, 0x80, v128
    v_and_or_b32 v128, v128, s50, v8
    v_add_u32 v129, 0x80, v129
    v_and_or_b32 v129, v129, s50, v8
    v_add_u32 v130, 0x80, v130
    v_and_or_b32 v130, v130, s50, v8
    v_add_u32 v131, 0x80, v131
    v_and_or_b32 v131, v131, s50, v8
    s_lshl_b32 s62, s56, 14
    s_lshl_b32 s63, s58, 12
    s_add_u32 s62, s62, s63
    s_lshl_b32 s63, s57, 8
    s_add_u32 s62, s62, s63
    s_add_u32 s62, s62, 4096
    buffer_store_dwordx4 v[128:131], v13, s[36:39], s62 offen sc1
    s_mov_b64 exec, -1
L_qpub_22:
    s_lshl_b32 s62, s56, 14
    s_lshl_b32 s63, s3, 10
    s_add_u32 s62, s62, s63
    s_add_u32 s62, s62, 4096
    v_lshlrev_b32 v13, 4, v2
    v_add_u32 v13, s62, v13
    s_sleep 48
    s_mov_b32 s78, 0
L_poll_23:
    s_mov_b32 s63, 0
    buffer_load_dwordx4 v[128:131], v13, s[36:39], s63 offen sc1
    s_mov_b32 s63, 4096
    buffer_load_dwordx4 v[132:135], v13, s[36:39], s63 offen sc1
    s_mov_b32 s63, 8192
    buffer_load_dwordx4 v[136:139], v13, s[36:39], s63 offen sc1
    s_mov_b32 s63, 12288
    buffer_load_dwordx4 v[140:143], v13, s[36:39], s63 offen sc1
    s_waitcnt vmcnt(0)
    v_xor_b32 v128, v128, v8
    v_xor_b32 v129, v129, v8
    v_xor_b32 v130, v130, v8
    v_xor_b32 v131, v131, v8
    v_xor_b32 v132, v132, v8
    v_xor_b32 v133, v133, v8
    v_xor_b32 v134, v134, v8
    v_xor_b32 v135, v135, v8
    v_xor_b32 v136, v136, v8
    v_xor_b32 v137, v137, v8
    v_xor_b32 v138, v138, v8
    v_xor_b32 v139, v139, v8
    v_xor_b32 v140, v140, v8
    v_xor_b32 v141, v141, v8
    v_xor_b32 v142, v142, v8
    v_xor_b32 v143, v143, v8
    v_or_b32 v29, v128, v129
    v_or3_b32 v29, v130, v131, v29
    v_or3_b32 v29, v132, v133, v29
    v_or3_b32 v29, v134, v135, v29
    v_or3_b32 v29, v136, v137, v29
    v_or3_b32 v29, v138, v139, v29
    v_or3_b32 v29, v140, v141, v29
    v_or3_b32 v29, v142, v143, v29
    v_and_b32 v29, 0xff, v29
    v_cmp_ne_u32 vcc, 0, v29
    s_add_u32 s78, s78, 1
    s_cbranch_vccz L_polld_24
    s_cmp_gt_u32 s78, 20000
    s_cbranch_scc1 L_polld_24
    s_sleep 6
    s_branch L_poll_23
L_polld_24:
    v_add_f32 v128, v128, v132
    v_add_f32 v136, v136, v140
    v_add_f32 v129, v129, v133
    v_add_f32 v137, v137, v141
    v_add_f32 v130, v130, v134
    v_add_f32 v138, v138, v142
    v_add_f32 v131, v131, v135
    v_add_f32 v139, v139, v143
    v_add_f32 v128, v128, v136
    v_add_f32 v129, v129, v137
    v_add_f32 v130, v130, v138
    v_add_f32 v131, v131, v139
    v_cvt_pk_bf16_f32 v132, v128, v129
    v_cvt_pk_bf16_f32 v133, v130, v131
    v_lshrrev_b32 v13, 5, v2
    s_lshl_b32 s62, s3, 1
    v_add_u32 v13, s62, v13
    v_mul_u32_u24 v13, 272, v13
    v_and_b32 v14, 31, v2
    v_lshlrev_b32 v14, 3, v14
    v_add_u32 v13, v13, v14
    ds_write_b64 v13, v[132:133] offset:256
    s_mov_b64 exec, 1
    ds_add_u32 v6, v7 offset:4
    s_mov_b64 exec, -1
    s_setprio 0
    s_load_dwordx2 s[20:21], s[0:1], 32
    s_mov_b32 s22, 8388608
    s_mov_b32 s23, 0x20000
    s_and_b32 s64, s2, 7
    s_lshl_b32 s64, s64, 2
    s_bfe_u32 s65, s2, 0x20003
    s_add_u32 s64, s64, s65
    s_lshl_b32 s66, s64, 7
    s_lshl_b32 s65, s3, 1
    s_add_u32 s66, s66, s65
    s_lshl_b32 s66, s66, 11
    s_lshr_b32 s65, s2, 5
    s_lshl_b32 s65, s65, 8
    s_add_u32 s66, s66, s65
    v_bfe_u32 v9, v2, 4, 1
    v_lshlrev_b32 v9, 6, v9
    v_lshrrev_b32 v10, 5, v2
    v_add_u32 v9, v9, v10
    v_lshlrev_b32 v9, 11, v9
    v_and_b32 v10, 15, v2
    v_lshlrev_b32 v10, 4, v10
    v_add_u32 v9, v9, v10
    s_waitcnt lgkmcnt(0)
    buffer_load_dwordx4 v[16:19], v9, s[20:23], s66 offen nt
    s_add_u32 s66, s66, 16384
    buffer_load_dwordx4 v[20:23], v9, s[20:23], s66 offen nt
    s_add_u32 s66, s66, 16384
    s_waitcnt vmcnt(1)
    buffer_load_dwordx4 v[24:27], v9, s[20:23], s66 offen nt
    s_add_u32 s66, s66, 16384
    buffer_load_dwordx4 v[28:31], v9, s[20:23], s66 offen nt
    s_add_u32 s66, s66, 16384
    s_waitcnt vmcnt(1)
    buffer_load_dwordx4 v[32:35], v9, s[20:23], s66 offen nt
    s_add_u32 s66, s66, 16384
    buffer_load_dwordx4 v[36:39], v9, s[20:23], s66 offen nt
    s_add_u32 s66, s66, 16384
    s_waitcnt vmcnt(1)
    buffer_load_dwordx4 v[40:43], v9, s[20:23], s66 offen nt
    s_add_u32 s66, s66, 16384
    buffer_load_dwordx4 v[44:47], v9, s[20:23], s66 offen nt
    s_waitcnt vmcnt(0)
    v_perm_b32 v48, v20, v16, s52
    v_perm_b32 v52, v20, v16, s53
    v_perm_b32 v49, v28, v24, s52
    v_perm_b32 v53, v28, v24, s53
    v_perm_b32 v50, v36, v32, s52
    v_perm_b32 v54, v36, v32, s53
    v_perm_b32 v51, v44, v40, s52
    v_perm_b32 v55, v44, v40, s53
    v_perm_b32 v56, v21, v17, s52
    v_perm_b32 v60, v21, v17, s53
    v_perm_b32 v57, v29, v25, s52
    v_perm_b32 v61, v29, v25, s53
    v_perm_b32 v58, v37, v33, s52
    v_perm_b32 v62, v37, v33, s53
    v_perm_b32 v59, v45, v41, s52
    v_perm_b32 v63, v45, v41, s53
    v_perm_b32 v64, v22, v18, s52
    v_perm_b32 v68, v22, v18, s53
    v_perm_b32 v65, v30, v26, s52
    v_perm_b32 v69, v30, v26, s53
    v_perm_b32 v66, v38, v34, s52
    v_perm_b32 v70, v38, v34, s53
    v_perm_b32 v67, v46, v42, s52
    v_perm_b32 v71, v46, v42, s53
    v_perm_b32 v72, v23, v19, s52
    v_perm_b32 v76, v23, v19, s53
    v_perm_b32 v73, v31, v27, s52
    v_perm_b32 v77, v31, v27, s53
    v_perm_b32 v74, v39, v35, s52
    v_perm_b32 v78, v39, v35, s53
    v_perm_b32 v75, v47, v43, s52
    v_perm_b32 v79, v47, v43, s53
    v_lshlrev_b32 v9, 4, v2
    s_lshl_b32 s65, s3, 13
    v_add_u32 v9, s65, v9
    ds_write_b128 v9, v[48:51] offset:31232
    ds_write_b128 v9, v[52:55] offset:32256
    ds_write_b128 v9, v[56:59] offset:33280
    ds_write_b128 v9, v[60:63] offset:34304
    ds_write_b128 v9, v[64:67] offset:35328
    ds_write_b128 v9, v[68:71] offset:36352
    ds_write_b128 v9, v[72:75] offset:37376
    ds_write_b128 v9, v[76:79] offset:38400
    s_mov_b64 exec, 1
    ds_add_u32 v6, v7 offset:44
    s_mov_b64 exec, -1
    s_cmp_eq_u32 s3, 0
    s_cbranch_scc0 L_nogo_25
L_lw_26:
    ds_read_b32 v10, v6 offset:36
    s_waitcnt lgkmcnt(0)
    v_readfirstlane_b32 s79, v10
    s_nop 0
    s_cmp_ge_u32 s79, 4
    s_cbranch_scc1 L_lwd_27
    s_sleep 2
    s_branch L_lw_26
L_lwd_27:
    s_mov_b64 exec, 1
    ds_add_u32 v6, v7 offset:12
    s_mov_b64 exec, -1
L_nogo_25:
    s_lshr_b32 s64, s2, 3
    s_and_b32 s65, s2, 7
    s_cmp_ge_u32 s64, 28
    s_cbranch_scc1 L_final_28
    s_lshl_b32 s66, s65, 7
    s_lshl_b32 s67, s3, 5
    s_add_u32 s66, s66, s67
    s_mul_i32 s67, s66, 7168
    s_lshl_b32 s68, s64, 8
    s_add_u32 s67, s67, s68
    v_lshrrev_b32 v9, 4, v2
    v_mul_u32_u24 v10, 57344, v9
    v_and_b32 v11, 15, v2
    v_lshlrev_b32 v12, 4, v11
    v_add_u32 v10, v10, v12
    v_lshlrev_b32 v12, 4, v9
    s_lshl_b32 s68, s66, 1
    buffer_load_dwordx4 v[144:147], v12, s[40:43], s68 offen
L_lw_30:
    ds_read_b32 v13, v6 offset:12
    s_waitcnt lgkmcnt(0)
    v_readfirstlane_b32 s79, v13
    s_nop 0
    s_cmp_ge_u32 s79, 1
    s_cbranch_scc1 L_lwd_31
    s_sleep 2
    s_branch L_lw_30
L_lwd_31:
    buffer_load_dwordx4 v[16:19], v10, s[24:27], s67 offen nt
    buffer_load_dwordx4 v[48:51], v10, s[28:31], s67 offen nt
    s_add_u32 s67, s67, 7168
    s_waitcnt vmcnt(2)
    buffer_load_dwordx4 v[20:23], v10, s[24:27], s67 offen nt
    buffer_load_dwordx4 v[52:55], v10, s[28:31], s67 offen nt
    s_add_u32 s67, s67, 7168
    s_waitcnt vmcnt(2)
    buffer_load_dwordx4 v[24:27], v10, s[24:27], s67 offen nt
    buffer_load_dwordx4 v[56:59], v10, s[28:31], s67 offen nt
    s_add_u32 s67, s67, 7168
    s_waitcnt vmcnt(2)
    buffer_load_dwordx4 v[28:31], v10, s[24:27], s67 offen nt
    buffer_load_dwordx4 v[60:63], v10, s[28:31], s67 offen nt
    s_add_u32 s67, s67, 7168
    s_waitcnt vmcnt(2)
    buffer_load_dwordx4 v[32:35], v10, s[24:27], s67 offen nt
    buffer_load_dwordx4 v[64:67], v10, s[28:31], s67 offen nt
    s_add_u32 s67, s67, 7168
    s_waitcnt vmcnt(2)
    buffer_load_dwordx4 v[36:39], v10, s[24:27], s67 offen nt
    buffer_load_dwordx4 v[68:71], v10, s[28:31], s67 offen nt
    s_add_u32 s67, s67, 7168
    s_waitcnt vmcnt(2)
    buffer_load_dwordx4 v[40:43], v10, s[24:27], s67 offen nt
    buffer_load_dwordx4 v[72:75], v10, s[28:31], s67 offen nt
    s_add_u32 s67, s67, 7168
    s_waitcnt vmcnt(2)
    buffer_load_dwordx4 v[44:47], v10, s[24:27], s67 offen nt
    buffer_load_dwordx4 v[76:79], v10, s[28:31], s67 offen nt
    v_and_b32 v13, 7, v2
    v_lshlrev_b32 v13, 12, v13
    v_lshlrev_b32 v14, 5, v9
    v_bfe_u32 v15, v2, 3, 1
    v_lshlrev_b32 v15, 4, v15
    v_add3_u32 v13, v13, v14, v15
    s_lshl_b32 s68, s66, 2
    s_add_u32 s68, s68, 131072
    v_cmp_eq_u32 s[70:71], 1, v11
    v_lshlrev_b32 v156, 7, v2
    s_lshl_b32 s72, s3, 11
    s_add_u32 s72, s72, 6144
    v_add_u32 v156, s72, v156
    v_lshlrev_b32 v157, 4, v2
    s_lshl_b32 s72, s64, 3
    s_add_u32 s72, s72, s65
    s_lshl_b32 s73, s72, 2
    s_add_u32 s73, s73, s3
    s_lshl_b32 s73, s73, 4
    s_add_u32 s73, s73, 102400
    s_lshl_b32 s72, s72, 11
    s_add_u32 s72, s72, 393216
    v_mov_b32 v158, 0x3f803f80
    s_waitcnt vmcnt(0)
    v_perm_b32 v80, v20, v16, s52
    v_perm_b32 v84, v20, v16, s53
    v_perm_b32 v81, v28, v24, s52
    v_perm_b32 v85, v28, v24, s53
    v_perm_b32 v82, v36, v32, s52
    v_perm_b32 v86, v36, v32, s53
    v_perm_b32 v83, v44, v40, s52
    v_perm_b32 v87, v44, v40, s53
    v_perm_b32 v88, v21, v17, s52
    v_perm_b32 v92, v21, v17, s53
    v_perm_b32 v89, v29, v25, s52
    v_perm_b32 v93, v29, v25, s53
    v_perm_b32 v90, v37, v33, s52
    v_perm_b32 v94, v37, v33, s53
    v_perm_b32 v91, v45, v41, s52
    v_perm_b32 v95, v45, v41, s53
    v_perm_b32 v96, v22, v18, s52
    v_perm_b32 v100, v22, v18, s53
    v_perm_b32 v97, v30, v26, s52
    v_perm_b32 v101, v30, v26, s53
    v_perm_b32 v98, v38, v34, s52
    v_perm_b32 v102, v38, v34, s53
    v_perm_b32 v99, v46, v42, s52
    v_perm_b32 v103, v46, v42, s53
    v_perm_b32 v104, v23, v19, s52
    v_perm_b32 v108, v23, v19, s53
    v_perm_b32 v105, v31, v27, s52
    v_perm_b32 v109, v31, v27, s53
    v_perm_b32 v106, v39, v35, s52
    v_perm_b32 v110, v39, v35, s53
    v_perm_b32 v107, v47, v43, s52
    v_perm_b32 v111, v47, v43, s53
    v_perm_b32 v112, v52, v48, s52
    v_perm_b32 v116, v52, v48, s53
    v_perm_b32 v113, v60, v56, s52
    v_perm_b32 v117, v60, v56, s53
    v_perm_b32 v114, v68, v64, s52
    v_perm_b32 v118, v68, v64, s53
    v_perm_b32 v115, v76, v72, s52
    v_perm_b32 v119, v76, v72, s53
    v_perm_b32 v120, v53, v49, s52
    v_perm_b32 v124, v53, v49, s53
    v_perm_b32 v121, v61, v57, s52
    v_perm_b32 v125, v61, v57, s53
    v_perm_b32 v122, v69, v65, s52
    v_perm_b32 v126, v69, v65, s53
    v_perm_b32 v123, v77, v73, s52
    v_perm_b32 v127, v77, v73, s53
    v_perm_b32 v128, v54, v50, s52
    v_perm_b32 v132, v54, v50, s53
    v_perm_b32 v129, v62, v58, s52
    v_perm_b32 v133, v62, v58, s53
    v_perm_b32 v130, v70, v66, s52
    v_perm_b32 v134, v70, v66, s53
    v_perm_b32 v131, v78, v74, s52
    v_perm_b32 v135, v78, v74, s53
    v_perm_b32 v136, v55, v51, s52
    v_perm_b32 v140, v55, v51, s53
    v_perm_b32 v137, v63, v59, s52
    v_perm_b32 v141, v63, v59, s53
    v_perm_b32 v138, v71, v67, s52
    v_perm_b32 v142, v71, v67, s53
    v_perm_b32 v139, v79, v75, s52
    v_perm_b32 v143, v79, v75, s53
    v_lshlrev_b32 v148, 16, v144
    v_and_b32 v149, 0xffff0000, v144
    v_lshlrev_b32 v150, 16, v145
    v_and_b32 v151, 0xffff0000, v145
    v_lshlrev_b32 v152, 16, v146
    v_and_b32 v153, 0xffff0000, v146
    v_lshlrev_b32 v154, 16, v147
    v_and_b32 v155, 0xffff0000, v147
L_lw_32:
    ds_read_b32 v15, v6 offset:20
    s_waitcnt lgkmcnt(0)
    v_readfirstlane_b32 s79, v15
    s_nop 0
    s_cmp_ge_u32 s79, 1
    s_cbranch_scc1 L_lwd_33
    s_sleep 1
    s_branch L_lw_32
L_lwd_33:
    s_sleep 14
    s_add_u32 s69, s68, 0
    buffer_load_dwordx4 v[16:19], v13, s[36:39], s69 offen sc1
    s_add_u32 s69, s68, 32768
    buffer_load_dwordx4 v[20:23], v13, s[36:39], s69 offen sc1
    s_add_u32 s69, s68, 65536
    buffer_load_dwordx4 v[24:27], v13, s[36:39], s69 offen sc1
    s_add_u32 s69, s68, 98304
    buffer_load_dwordx4 v[28:31], v13, s[36:39], s69 offen sc1
    s_mov_b32 s78, 0
L_s3re_34:
    s_waitcnt vmcnt(0)
    v_xor_b32 v16, v16, v8
    v_xor_b32 v17, v17, v8
    v_xor_b32 v18, v18, v8
    v_xor_b32 v19, v19, v8
    v_xor_b32 v20, v20, v8
    v_xor_b32 v21, v21, v8
    v_xor_b32 v22, v22, v8
    v_xor_b32 v23, v23, v8
    v_xor_b32 v24, v24, v8
    v_xor_b32 v25, v25, v8
    v_xor_b32 v26, v26, v8
    v_xor_b32 v27, v27, v8
    v_xor_b32 v28, v28, v8
    v_xor_b32 v29, v29, v8
    v_xor_b32 v30, v30, v8
    v_xor_b32 v31, v31, v8
    v_pk_add_f32 v[32:33], v[16:17], v[20:21]
    v_pk_add_f32 v[36:37], v[24:25], v[28:29]
    v_pk_add_f32 v[34:35], v[18:19], v[22:23]
    v_pk_add_f32 v[38:39], v[26:27], v[30:31]
    v_pk_add_f32 v[32:33], v[32:33], v[36:37]
    v_pk_add_f32 v[34:35], v[34:35], v[38:39]
    s_nop 0
    v_add_f32_dpp v32, v32, v32 quad_perm:[1,0,3,2] row_mask:0xf bank_mask:0xf
    v_add_f32_dpp v33, v33, v33 quad_perm:[1,0,3,2] row_mask:0xf bank_mask:0xf
    v_add_f32_dpp v34, v34, v34 quad_perm:[1,0,3,2] row_mask:0xf bank_mask:0xf
    v_add_f32_dpp v35, v35, v35 quad_perm:[1,0,3,2] row_mask:0xf bank_mask:0xf
    v_or3_b32 v15, v16, v17, v18
    v_or3_b32 v15, v19, v20, v15
    v_or3_b32 v15, v21, v22, v15
    v_add_f32_dpp v32, v32, v32 quad_perm:[2,3,0,1] row_mask:0xf bank_mask:0xf
    v_add_f32_dpp v33, v33, v33 quad_perm:[2,3,0,1] row_mask:0xf bank_mask:0xf
    v_add_f32_dpp v34, v34, v34 quad_perm:[2,3,0,1] row_mask:0xf bank_mask:0xf
    v_add_f32_dpp v35, v35, v35 quad_perm:[2,3,0,1] row_mask:0xf bank_mask:0xf
    v_or3_b32 v15, v23, v24, v15
    v_or3_b32 v15, v25, v26, v15
    v_or3_b32 v15, v27, v28, v15
    v_add_f32_dpp v32, v32, v32 row_half_mirror row_mask:0xf bank_mask:0xf
    v_add_f32_dpp v33, v33, v33 row_half_mirror row_mask:0xf bank_mask:0xf
    v_add_f32_dpp v34, v34, v34 row_half_mirror row_mask:0xf bank_mask:0xf
    v_add_f32_dpp v35, v35, v35 row_half_mirror row_mask:0xf bank_mask:0xf
    v_or3_b32 v15, v29, v30, v15
    v_or_b32 v15, v31, v15
    v_mov_b32_dpp v36, v32 row_ror:8 row_mask:0xf bank_mask:0xf
    v_mov_b32_dpp v37, v33 row_ror:8 row_mask:0xf bank_mask:0xf
    v_mov_b32_dpp v38, v34 row_ror:8 row_mask:0xf bank_mask:0xf
    v_mov_b32_dpp v39, v35 row_ror:8 row_mask:0xf bank_mask:0xf
    v_and_b32 v15, 0xff, v15
    v_cmp_ne_u32 vcc, 0, v15
    v_cvt_pk_bf16_f32 v40, v32, v33
    v_cvt_pk_bf16_f32 v41, v34, v35
    v_cvt_pk_bf16_f32 v42, v36, v37
    v_cvt_pk_bf16_f32 v43, v38, v39
    s_cbranch_vccz L_s3ok_35
    s_add_u32 s78, s78, 1
    s_cmp_gt_u32 s78, 20000
    s_cbranch_scc1 L_s3ok_35
    s_sleep 1
    s_add_u32 s69, s68, 0
    buffer_load_dwordx4 v[16:19], v13, s[36:39], s69 offen sc1
    s_add_u32 s69, s68, 32768
    buffer_load_dwordx4 v[20:23], v13, s[36:39], s69 offen sc1
    s_add_u32 s69, s68, 65536
    buffer_load_dwordx4 v[24:27], v13, s[36:39], s69 offen sc1
    s_add_u32 s69, s68, 98304
    buffer_load_dwordx4 v[28:31], v13, s[36:39], s69 offen sc1
    s_branch L_s3re_34
L_s3ok_35:
    v_lshlrev_b32 v32, 16, v40
    v_and_b32 v33, 0xffff0000, v40
    v_lshlrev_b32 v34, 16, v41
    v_and_b32 v35, 0xffff0000, v41
    v_lshlrev_b32 v36, 16, v42
    v_and_b32 v37, 0xffff0000, v42
    v_lshlrev_b32 v38, 16, v43
    v_and_b32 v39, 0xffff0000, v43
    v_pk_add_f32 v[32:33], v[32:33], v[148:149]
    v_pk_add_f32 v[34:35], v[34:35], v[150:151]
    v_pk_add_f32 v[36:37], v[36:37], v[152:153]
    v_pk_add_f32 v[38:39], v[38:39], v[154:155]
    v_cvt_pk_bf16_f32 v44, v32, v33
    v_cvt_pk_bf16_f32 v45, v34, v35
    v_cvt_pk_bf16_f32 v46, v36, v37
    v_cvt_pk_bf16_f32 v47, v38, v39
    v_cndmask_b32 v48, v44, v158, s[70:71]
    v_cndmask_b32 v49, v45, v158, s[70:71]
    v_cndmask_b32 v50, v46, v158, s[70:71]
    v_cndmask_b32 v51, v47, v158, s[70:71]
    s_nop 1
    v_mfma_f32_16x16x32_bf16 v[160:163], v[48:51], v[80:83], 0
    v_mfma_f32_16x16x32_bf16 v[192:195], v[48:51], v[112:115], 0
    v_lshlrev_b32 v32, 16, v44
    v_and_b32 v33, 0xffff0000, v44
    v_lshlrev_b32 v34, 16, v45
    v_and_b32 v35, 0xffff0000, v45
    v_lshlrev_b32 v36, 16, v46
    v_and_b32 v37, 0xffff0000, v46
    v_lshlrev_b32 v38, 16, v47
    v_and_b32 v39, 0xffff0000, v47
    v_mfma_f32_16x16x32_bf16 v[164:167], v[48:51], v[84:87], 0
    v_mfma_f32_16x16x32_bf16 v[196:199], v[48:51], v[116:119], 0
    v_pk_add_f32 v[52:53], v[32:33], v[34:35]
    v_pk_add_f32 v[54:55], v[36:37], v[38:39]
    v_pk_mul_f32 v[56:57], v[32:33], v[32:33]
    v_mfma_f32_16x16x32_bf16 v[168:171], v[48:51], v[88:91], 0
    v_mfma_f32_16x16x32_bf16 v[200:203], v[48:51], v[120:123], 0
    v_pk_add_f32 v[52:53], v[52:53], v[54:55]
    v_pk_fma_f32 v[56:57], v[34:35], v[34:35], v[56:57]
    v_pk_fma_f32 v[56:57], v[36:37], v[36:37], v[56:57]
    v_pk_fma_f32 v[56:57], v[38:39], v[38:39], v[56:57]
    v_mfma_f32_16x16x32_bf16 v[172:175], v[48:51], v[92:95], 0
    v_mfma_f32_16x16x32_bf16 v[204:207], v[48:51], v[124:127], 0
    v_add_f32 v52, v52, v53
    v_add_f32 v56, v56, v57
    v_mov_b32 v53, v52
    v_mov_b32 v57, v56
    v_mfma_f32_16x16x32_bf16 v[176:179], v[48:51], v[96:99], 0
    v_mfma_f32_16x16x32_bf16 v[208:211], v[48:51], v[128:131], 0
    v_permlane16_swap_b32 v53, v52
    v_permlane16_swap_b32 v57, v56
    v_add_f32 v52, v52, v53
    v_add_f32 v56, v56, v57
    v_mov_b32 v53, v52
    v_mov_b32 v57, v56
    v_mfma_f32_16x16x32_bf16 v[180:183], v[48:51], v[100:103], 0
    v_mfma_f32_16x16x32_bf16 v[212:215], v[48:51], v[132:135], 0
    v_permlane32_swap_b32 v53, v52
    v_permlane32_swap_b32 v57, v56
    v_add_f32 v52, v52, v53
    v_add_f32 v56, v56, v57
    v_mfma_f32_16x16x32_bf16 v[184:187], v[48:51], v[104:107], 0
    v_mfma_f32_16x16x32_bf16 v[216:219], v[48:51], v[136:139], 0
    v_and_b32 v60, s50, v52
    v_and_b32 v62, s50, v56
    v_sub_f32 v61, v52, v60
    v_sub_f32 v63, v56, v62
    v_mfma_f32_16x16x32_bf16 v[188:191], v[48:51], v[108:111], 0
    v_mfma_f32_16x16x32_bf16 v[220:223], v[48:51], v[140:143], 0
    v_and_or_b32 v60, v60, s50, v8
    v_and_or_b32 v61, v61, s50, v8
    v_and_or_b32 v62, v62, s50, v8
    v_and_or_b32 v63, v63, s50, v8
    s_mov_b64 exec, 1
    buffer_store_dwordx4 v[60:63], v6, s[36:39], s73 offen sc1
    s_mov_b64 exec, 0xffff
    ds_write2_b64 v156, v[160:161], v[192:193] offset0:0 offset1:1
    ds_write2_b64 v156, v[164:165], v[196:197] offset0:2 offset1:3
    ds_write2_b64 v156, v[168:169], v[200:201] offset0:4 offset1:5
    ds_write2_b64 v156, v[172:173], v[204:205] offset0:6 offset1:7
    ds_write2_b64 v156, v[176:177], v[208:209] offset0:8 offset1:9
    ds_write2_b64 v156, v[180:181], v[212:213] offset0:10 offset1:11
    ds_write2_b64 v156, v[184:185], v[216:217] offset0:12 offset1:13
    ds_write2_b64 v156, v[188:189], v[220:221] offset0:14 offset1:15
    s_mov_b64 exec, 1
    ds_add_rtn_u32 v15, v6, v7 offset:24
    s_mov_b64 exec, -1
    s_waitcnt lgkmcnt(0)
    v_readfirstlane_b32 s66, v15
    s_nop 0
    s_cmp_eq_u32 s66, 3
    s_cbranch_scc0 L_s3p_36
    ds_read_b128 v[64:67], v157 offset:6144
    ds_read_b128 v[68:71], v157 offset:8192
    ds_read_b128 v[72:75], v157 offset:10240
    ds_read_b128 v[76:79], v157 offset:12288
    ds_read_b128 v[80:83], v157 offset:7168
    ds_read_b128 v[84:87], v157 offset:9216
    ds_read_b128 v[88:91], v157 offset:11264
    ds_read_b128 v[92:95], v157 offset:13312
    s_waitcnt lgkmcnt(0)
    v_pk_add_f32 v[64:65], v[64:65], v[68:69]
    v_pk_add_f32 v[72:73], v[72:73], v[76:77]
    v_pk_add_f32 v[66:67], v[66:67], v[70:71]
    v_pk_add_f32 v[74:75], v[74:75], v[78:79]
    v_pk_add_f32 v[64:65], v[64:65], v[72:73]
    v_pk_add_f32 v[66:67], v[66:67], v[74:75]
    v_and_or_b32 v64, v64, s50, v8
    v_and_or_b32 v65, v65, s50, v8
    v_and_or_b32 v66, v66, s50, v8
    v_and_or_b32 v67, v67, s50, v8
    buffer_store_dwordx4 v[64:67], v157, s[36:39], s72 offen offset:0 sc1
    v_pk_add_f32 v[80:81], v[80:81], v[84:85]
    v_pk_add_f32 v[88:89], v[88:89], v[92:93]
    v_pk_add_f32 v[82:83], v[82:83], v[86:87]
    v_pk_add_f32 v[90:91], v[90:91], v[94:95]
    v_pk_add_f32 v[80:81], v[80:81], v[88:89]
    v_pk_add_f32 v[82:83], v[82:83], v[90:91]
    v_and_or_b32 v80, v80, s50, v8
    v_and_or_b32 v81, v81, s50, v8
    v_and_or_b32 v82, v82, s50, v8
    v_and_or_b32 v83, v83, s50, v8
    buffer_store_dwordx4 v[80:83], v157, s[36:39], s72 offen offset:1024 sc1
    s_mov_b64 exec, 1
    ds_add_u32 v6, v7 offset:28
    s_mov_b64 exec, -1
L_s3p_36:
    s_branch L_hexit_29
L_final_28:
    s_cmp_eq_u32 s3, 0
    s_cbranch_scc0 L_hexit_29
    s_sub_u32 s66, s64, 28
    s_lshl_b32 s66, s66, 5
    s_lshl_b32 s67, s65, 7
    s_add_u32 s66, s66, s67
    v_lshrrev_b32 v9, 3, v2
    v_lshlrev_b32 v9, 12, v9
    v_and_b32 v10, 7, v2
    v_lshlrev_b32 v11, 4, v10
    v_add_u32 v9, v9, v11
    v_lshlrev_b32 v11, 3, v10
    s_lshl_b32 s67, s66, 1
    buffer_load_dwordx2 v[16:17], v11, s[40:43], s67 offen
    s_lshl_b32 s68, s66, 2
    s_add_u32 s69, s68, 262144
    s_add_u32 s68, s68, 131072
L_lw_37:
    ds_read_b32 v15, v6 offset:20
    s_waitcnt lgkmcnt(0)
    v_readfirstlane_b32 s79, v15
    s_nop 0
    s_cmp_ge_u32 s79, 1
    s_cbranch_scc1 L_lwd_38
    s_sleep 1
    s_branch L_lw_37
L_lwd_38:
    s_sleep 14
    s_add_u32 s70, s68, 0
    buffer_load_dwordx4 v[32:35], v9, s[36:39], s70 offen sc1
    s_add_u32 s70, s68, 32768
    buffer_load_dwordx4 v[36:39], v9, s[36:39], s70 offen sc1
    s_add_u32 s70, s68, 65536
    buffer_load_dwordx4 v[40:43], v9, s[36:39], s70 offen sc1
    s_add_u32 s70, s68, 98304
    buffer_load_dwordx4 v[44:47], v9, s[36:39], s70 offen sc1
    s_waitcnt vmcnt(0)
    s_mov_b32 s78, 0
    v_xor_b32 v32, v32, v8
    v_xor_b32 v33, v33, v8
    v_xor_b32 v34, v34, v8
    v_xor_b32 v35, v35, v8
    v_xor_b32 v36, v36, v8
    v_xor_b32 v37, v37, v8
    v_xor_b32 v38, v38, v8
    v_xor_b32 v39, v39, v8
    v_xor_b32 v40, v40, v8
    v_xor_b32 v41, v41, v8
    v_xor_b32 v42, v42, v8
    v_xor_b32 v43, v43, v8
    v_xor_b32 v44, v44, v8
    v_xor_b32 v45, v45, v8
    v_xor_b32 v46, v46, v8
    v_xor_b32 v47, v47, v8
    v_or_b32 v15, v32, v33
    v_or3_b32 v15, v34, v35, v15
    v_or3_b32 v15, v36, v37, v15
    v_or3_b32 v15, v38, v39, v15
    v_or3_b32 v15, v40, v41, v15
    v_or3_b32 v15, v42, v43, v15
    v_or3_b32 v15, v44, v45, v15
    v_or3_b32 v15, v46, v47, v15
    v_and_b32 v15, 0xff, v15
    v_cmp_ne_u32 vcc, 0, v15
    s_cbranch_vccz L_mpd_40
    v_or3_b32 v15, v32, v33, v34
    v_or_b32 v15, v15, v35
    v_and_b32 v15, 0xff, v15
    v_cmp_ne_u32 s[8:9], 0, v15
    v_or3_b32 v15, v36, v37, v38
    v_or_b32 v15, v15, v39
    v_and_b32 v15, 0xff, v15
    v_cmp_ne_u32 s[10:11], 0, v15
    v_or3_b32 v15, v40, v41, v42
    v_or_b32 v15, v15, v43
    v_and_b32 v15, 0xff, v15
    v_cmp_ne_u32 s[12:13], 0, v15
    v_or3_b32 v15, v44, v45, v46
    v_or_b32 v15, v15, v47
    v_and_b32 v15, 0xff, v15
    v_cmp_ne_u32 s[14:15], 0, v15
L_mp_39:
    s_sleep 1
L_mpi_41:
    s_mov_b64 exec, s[8:9]
    s_cbranch_execz L_mps_42
    s_add_u32 s70, s68, 0
    buffer_load_dwordx4 v[32:35], v9, s[36:39], s70 offen sc1
L_mps_42:
    s_mov_b64 exec, s[10:11]
    s_cbranch_execz L_mps_43
    s_add_u32 s70, s68, 32768
    buffer_load_dwordx4 v[36:39], v9, s[36:39], s70 offen sc1
L_mps_43:
    s_mov_b64 exec, s[12:13]
    s_cbranch_execz L_mps_44
    s_add_u32 s70, s68, 65536
    buffer_load_dwordx4 v[40:43], v9, s[36:39], s70 offen sc1
L_mps_44:
    s_mov_b64 exec, s[14:15]
    s_cbranch_execz L_mps_45
    s_add_u32 s70, s68, 98304
    buffer_load_dwordx4 v[44:47], v9, s[36:39], s70 offen sc1
L_mps_45:
    s_mov_b64 exec, -1
    s_waitcnt vmcnt(0)
    s_mov_b64 s[16:17], 0
    s_mov_b64 exec, s[8:9]
    s_cbranch_execz L_mpc_46
    v_xor_b32 v32, v32, v8
    v_xor_b32 v33, v33, v8
    v_xor_b32 v34, v34, v8
    v_xor_b32 v35, v35, v8
    v_or3_b32 v15, v32, v33, v34
    v_or_b32 v15, v15, v35
    v_and_b32 v15, 0xff, v15
    v_cmp_ne_u32 vcc, 0, v15
    s_nop 0
    s_mov_b64 s[8:9], vcc
    s_or_b64 s[16:17], s[16:17], vcc
L_mpc_46:
    s_mov_b64 exec, s[10:11]
    s_cbranch_execz L_mpc_47
    v_xor_b32 v36, v36, v8
    v_xor_b32 v37, v37, v8
    v_xor_b32 v38, v38, v8
    v_xor_b32 v39, v39, v8
    v_or3_b32 v15, v36, v37, v38
    v_or_b32 v15, v15, v39
    v_and_b32 v15, 0xff, v15
    v_cmp_ne_u32 vcc, 0, v15
    s_nop 0
    s_mov_b64 s[10:11], vcc
    s_or_b64 s[16:17], s[16:17], vcc
L_mpc_47:
    s_mov_b64 exec, s[12:13]
    s_cbranch_execz L_mpc_48
    v_xor_b32 v40, v40, v8
    v_xor_b32 v41, v41, v8
    v_xor_b32 v42, v42, v8
    v_xor_b32 v43, v43, v8
    v_or3_b32 v15, v40, v41, v42
    v_or_b32 v15, v15, v43
    v_and_b32 v15, 0xff, v15
    v_cmp_ne_u32 vcc, 0, v15
    s_nop 0
    s_mov_b64 s[12:13], vcc
    s_or_b64 s[16:17], s[16:17], vcc
L_mpc_48:
    s_mov_b64 exec, s[14:15]
    s_cbranch_execz L_mpc_49
    v_xor_b32 v44, v44, v8
    v_xor_b32 v45, v45, v8
    v_xor_b32 v46, v46, v8
    v_xor_b32 v47, v47, v8
    v_or3_b32 v15, v44, v45, v46
    v_or_b32 v15, v15, v47
    v_and_b32 v15, 0xff, v15
    v_cmp_ne_u32 vcc, 0, v15
    s_nop 0
    s_mov_b64 s[14:15], vcc
    s_or_b64 s[16:17], s[16:17], vcc
L_mpc_49:
    s_mov_b64 exec, -1
    s_add_u32 s78, s78, 1
    s_cmp_gt_u32 s78, 20000
    s_cbranch_scc1 L_mpd_40
    s_cmp_lg_u64 s[16:17], 0
    s_cbranch_scc1 L_mp_39
L_mpd_40:
    v_add_f32 v32, v32, v36
    v_add_f32 v40, v40, v44
    v_add_f32 v33, v33, v37
    v_add_f32 v41, v41, v45
    v_add_f32 v34, v34, v38
    v_add_f32 v42, v42, v46
    v_add_f32 v35, v35, v39
    v_add_f32 v43, v43, v47
    v_add_f32 v32, v32, v40
    v_add_f32 v33, v33, v41
    v_add_f32 v34, v34, v42
    v_add_f32 v35, v35, v43
    v_add_f32_dpp v32, v32, v32 row_ror:8 row_mask:0xf bank_mask:0xf
    v_add_f32_dpp v33, v33, v33 row_ror:8 row_mask:0xf bank_mask:0xf
    v_add_f32_dpp v34, v34, v34 row_ror:8 row_mask:0xf bank_mask:0xf
    v_add_f32_dpp v35, v35, v35 row_ror:8 row_mask:0xf bank_mask:0xf
    v_mov_b32 v36, v32
    v_mov_b32 v37, v33
    v_mov_b32 v38, v34
    v_mov_b32 v39, v35
    v_permlane16_swap_b32 v36, v32
    v_permlane16_swap_b32 v37, v33
    v_permlane16_swap_b32 v38, v34
    v_permlane16_swap_b32 v39, v35
    v_add_f32 v32, v32, v36
    v_add_f32 v33, v33, v37
    v_add_f32 v34, v34, v38
    v_add_f32 v35, v35, v39
    v_mov_b32 v36, v32
    v_mov_b32 v37, v33
    v_mov_b32 v38, v34
    v_mov_b32 v39, v35
    v_permlane32_swap_b32 v36, v32
    v_permlane32_swap_b32 v37, v33
    v_permlane32_swap_b32 v38, v34
    v_permlane32_swap_b32 v39, v35
    v_add_f32 v32, v32, v36
    v_add_f32 v33, v33, v37
    v_add_f32 v34, v34, v38
    v_add_f32 v35, v35, v39
    v_cvt_pk_bf16_f32 v15, v32, v33
    v_and_b32 v33, 0xffff0000, v15
    v_lshlrev_b32 v32, 16, v15
    v_cvt_pk_bf16_f32 v15, v34, v35
    v_and_b32 v35, 0xffff0000, v15
    v_lshlrev_b32 v34, 16, v15
    v_lshlrev_b32 v20, 16, v16
    v_and_b32 v21, 0xffff0000, v16
    v_lshlrev_b32 v22, 16, v17
    v_and_b32 v23, 0xffff0000, v17
    v_add_f32 v32, v32, v20
    v_add_f32 v33, v33, v21
    v_add_f32 v34, v34, v22
    v_add_f32 v35, v35, v23
    v_cvt_pk_bf16_f32 v15, v32, v33
    v_and_b32 v33, 0xffff0000, v15
    v_lshlrev_b32 v32, 16, v15
    v_cvt_pk_bf16_f32 v15, v34, v35
    v_and_b32 v35, 0xffff0000, v15
    v_lshlrev_b32 v34, 16, v15
    s_sleep 60
    v_mov_b32 v76, v8
    v_mov_b32 v77, v8
    v_mov_b32 v78, v8
    v_mov_b32 v79, v8
    s_add_u32 s70, s69, 0
    buffer_load_dwordx4 v[64:67], v9, s[36:39], s70 offen sc1
    s_add_u32 s70, s69, 32768
    buffer_load_dwordx4 v[68:71], v9, s[36:39], s70 offen sc1
    s_add_u32 s70, s69, 65536
    buffer_load_dwordx4 v[72:75], v9, s[36:39], s70 offen sc1
    s_mov_b64 exec, 0xffffffff
    s_add_u32 s70, s69, 98304
    buffer_load_dwordx4 v[76:79], v9, s[36:39], s70 offen sc1
    s_mov_b64 exec, -1
    s_waitcnt vmcnt(0)
    s_mov_b32 s78, 0
    v_xor_b32 v64, v64, v8
    v_xor_b32 v65, v65, v8
    v_xor_b32 v66, v66, v8
    v_xor_b32 v67, v67, v8
    v_xor_b32 v68, v68, v8
    v_xor_b32 v69, v69, v8
    v_xor_b32 v70, v70, v8
    v_xor_b32 v71, v71, v8
    v_xor_b32 v72, v72, v8
    v_xor_b32 v73, v73, v8
    v_xor_b32 v74, v74, v8
    v_xor_b32 v75, v75, v8
    v_xor_b32 v76, v76, v8
    v_xor_b32 v77, v77, v8
    v_xor_b32 v78, v78, v8
    v_xor_b32 v79, v79, v8
    v_or_b32 v15, v64, v65
    v_or3_b32 v15, v66, v67, v15
    v_or3_b32 v15, v68, v69, v15
    v_or3_b32 v15, v70, v71, v15
    v_or3_b32 v15, v72, v73, v15
    v_or3_b32 v15, v74, v75, v15
    v_or3_b32 v15, v76, v77, v15
    v_or3_b32 v15, v78, v79, v15
    v_and_b32 v15, 0xff, v15
    v_cmp_ne_u32 vcc, 0, v15
    s_cbranch_vccz L_mpd_51
    v_or3_b32 v15, v64, v65, v66
    v_or_b32 v15, v15, v67
    v_and_b32 v15, 0xff, v15
    v_cmp_ne_u32 s[8:9], 0, v15
    v_or3_b32 v15, v68, v69, v70
    v_or_b32 v15, v15, v71
    v_and_b32 v15, 0xff, v15
    v_cmp_ne_u32 s[10:11], 0, v15
    v_or3_b32 v15, v72, v73, v74
    v_or_b32 v15, v15, v75
    v_and_b32 v15, 0xff, v15
    v_cmp_ne_u32 s[12:13], 0, v15
    v_or3_b32 v15, v76, v77, v78
    v_or_b32 v15, v15, v79
    v_and_b32 v15, 0xff, v15
    v_cmp_ne_u32 s[14:15], 0, v15
L_mp_50:
L_mpi_52:
    s_mov_b64 exec, s[8:9]
    s_cbranch_execz L_mps_53
    s_add_u32 s70, s69, 0
    buffer_load_dwordx4 v[64:67], v9, s[36:39], s70 offen sc1
L_mps_53:
    s_mov_b64 exec, s[10:11]
    s_cbranch_execz L_mps_54
    s_add_u32 s70, s69, 32768
    buffer_load_dwordx4 v[68:71], v9, s[36:39], s70 offen sc1
L_mps_54:
    s_mov_b64 exec, s[12:13]
    s_cbranch_execz L_mps_55
    s_add_u32 s70, s69, 65536
    buffer_load_dwordx4 v[72:75], v9, s[36:39], s70 offen sc1
L_mps_55:
    s_mov_b64 exec, s[14:15]
    s_cbranch_execz L_mps_56
    s_add_u32 s70, s69, 98304
    buffer_load_dwordx4 v[76:79], v9, s[36:39], s70 offen sc1
L_mps_56:
    s_mov_b64 exec, -1
    s_waitcnt vmcnt(0)
    s_mov_b64 s[16:17], 0
    s_mov_b64 exec, s[8:9]
    s_cbranch_execz L_mpc_57
    v_xor_b32 v64, v64, v8
    v_xor_b32 v65, v65, v8
    v_xor_b32 v66, v66, v8
    v_xor_b32 v67, v67, v8
    v_or3_b32 v15, v64, v65, v66
    v_or_b32 v15, v15, v67
    v_and_b32 v15, 0xff, v15
    v_cmp_ne_u32 vcc, 0, v15
    s_nop 0
    s_mov_b64 s[8:9], vcc
    s_or_b64 s[16:17], s[16:17], vcc
L_mpc_57:
    s_mov_b64 exec, s[10:11]
    s_cbranch_execz L_mpc_58
    v_xor_b32 v68, v68, v8
    v_xor_b32 v69, v69, v8
    v_xor_b32 v70, v70, v8
    v_xor_b32 v71, v71, v8
    v_or3_b32 v15, v68, v69, v70
    v_or_b32 v15, v15, v71
    v_and_b32 v15, 0xff, v15
    v_cmp_ne_u32 vcc, 0, v15
    s_nop 0
    s_mov_b64 s[10:11], vcc
    s_or_b64 s[16:17], s[16:17], vcc
L_mpc_58:
    s_mov_b64 exec, s[12:13]
    s_cbranch_execz L_mpc_59
    v_xor_b32 v72, v72, v8
    v_xor_b32 v73, v73, v8
    v_xor_b32 v74, v74, v8
    v_xor_b32 v75, v75, v8
    v_or3_b32 v15, v72, v73, v74
    v_or_b32 v15, v15, v75
    v_and_b32 v15, 0xff, v15
    v_cmp_ne_u32 vcc, 0, v15
    s_nop 0
    s_mov_b64 s[12:13], vcc
    s_or_b64 s[16:17], s[16:17], vcc
L_mpc_59:
    s_mov_b64 exec, s[14:15]
    s_cbranch_execz L_mpc_60
    v_xor_b32 v76, v76, v8
    v_xor_b32 v77, v77, v8
    v_xor_b32 v78, v78, v8
    v_xor_b32 v79, v79, v8
    v_or3_b32 v15, v76, v77, v78
    v_or_b32 v15, v15, v79
    v_and_b32 v15, 0xff, v15
    v_cmp_ne_u32 vcc, 0, v15
    s_nop 0
    s_mov_b64 s[14:15], vcc
    s_or_b64 s[16:17], s[16:17], vcc
L_mpc_60:
    s_mov_b64 exec, -1
    s_add_u32 s78, s78, 1
    s_cmp_gt_u32 s78, 20000
    s_cbranch_scc1 L_mpd_51
    s_cmp_lg_u64 s[16:17], 0
    s_cbranch_scc1 L_mp_50
L_mpd_51:
    v_add_f32 v64, v64, v68
    v_add_f32 v72, v72, v76
    v_add_f32 v65, v65, v69
    v_add_f32 v73, v73, v77
    v_add_f32 v66, v66, v70
    v_add_f32 v74, v74, v78
    v_add_f32 v67, v67, v71
    v_add_f32 v75, v75, v79
    v_add_f32 v64, v64, v72
    v_add_f32 v65, v65, v73
    v_add_f32 v66, v66, v74
    v_add_f32 v67, v67, v75
    v_add_f32_dpp v64, v64, v64 row_ror:8 row_mask:0xf bank_mask:0xf
    v_add_f32_dpp v65, v65, v65 row_ror:8 row_mask:0xf bank_mask:0xf
    v_add_f32_dpp v66, v66, v66 row_ror:8 row_mask:0xf bank_mask:0xf
    v_add_f32_dpp v67, v67, v67 row_ror:8 row_mask:0xf bank_mask:0xf
    v_mov_b32 v68, v64
    v_mov_b32 v69, v65
    v_mov_b32 v70, v66
    v_mov_b32 v71, v67
    v_permlane16_swap_b32 v68, v64
    v_permlane16_swap_b32 v69, v65
    v_permlane16_swap_b32 v70, v66
    v_permlane16_swap_b32 v71, v67
    v_add_f32 v64, v64, v68
    v_add_f32 v65, v65, v69
    v_add_f32 v66, v66, v70
    v_add_f32 v67, v67, v71
    v_mov_b32 v68, v64
    v_mov_b32 v69, v65
    v_mov_b32 v70, v66
    v_mov_b32 v71, v67
    v_permlane32_swap_b32 v68, v64
    v_permlane32_swap_b32 v69, v65
    v_permlane32_swap_b32 v70, v66
    v_permlane32_swap_b32 v71, v67
    v_add_f32 v64, v64, v68
    v_add_f32 v65, v65, v69
    v_add_f32 v66, v66, v70
    v_add_f32 v67, v67, v71
    v_cvt_pk_bf16_f32 v15, v64, v65
    v_and_b32 v65, 0xffff0000, v15
    v_lshlrev_b32 v64, 16, v15
    v_cvt_pk_bf16_f32 v15, v66, v67
    v_and_b32 v67, 0xffff0000, v15
    v_lshlrev_b32 v66, 16, v15
    v_add_f32 v64, v64, v32
    v_add_f32 v65, v65, v33
    v_add_f32 v66, v66, v34
    v_add_f32 v67, v67, v35
    v_cvt_pk_bf16_f32 v68, v64, v65
    v_cvt_pk_bf16_f32 v69, v66, v67
    s_mov_b64 exec, 0xff
    buffer_store_dwordx2 v[68:69], v11, s[44:47], s67 offen
    s_cmp_eq_u32 s2, 255
    s_cbranch_scc0 L_noepoch_61
    s_mov_b64 exec, 1
    v_mov_b32 v20, s49
    buffer_store_dword v20, v6, s[36:39], 0 offen sc1
L_noepoch_61:
    s_mov_b64 exec, -1
L_hexit_29:
    s_endpgm
L_end:
    s_endpgm
.section .rodata,"a"
.p2align 6
.amdhsa_kernel sequential_preLN__gqa_block_cached__geglu_ffn__decode_kernel
  .amdhsa_next_free_vgpr 256
  .amdhsa_next_free_sgpr 102
  .amdhsa_accum_offset 256
  .amdhsa_group_segment_fixed_size 0
  .amdhsa_kernarg_size 96
  .amdhsa_user_sgpr_count 2
  .amdhsa_user_sgpr_kernarg_segment_ptr 1
  .amdhsa_system_sgpr_workgroup_id_x 1
.end_amdhsa_kernel
```
